```python
import torch

def _softmax(x, axis=-1):
    return torch.softmax(x, dim=axis)
def _gelu(x):
    return torch.nn.functional.gelu(x, approximate="tanh")
def _silu(x):
    return torch.nn.functional.silu(x)
def _sigmoid(x):
    return torch.sigmoid(x)
def _layernorm(x, axis=-1, eps=1e-5):
    m = x.mean(dim=axis, keepdim=True)
    v = x.var(dim=axis, keepdim=True, unbiased=False)
    return (x - m) / torch.sqrt(v + eps)
def _scatter_add(tgt, idx, src, axis=0):
    return tgt.clone().index_add_(axis, idx, src)
def _segment_sum(src, seg, n):
    out = torch.zeros((n,) + src.shape[1:], dtype=src.dtype)
    return out.index_add_(0, seg, src)
def _pad(x, pw):
    flat = tuple(v for pair in reversed(pw) for v in pair)
    return torch.nn.functional.pad(x, flat)

kernel_name = 'standalone__kv_cache_quant_int4_int2_kv_with_per_channel_or_per_token_scales__prompt'

def setup_inputs():

    _w = (lambda a: (lambda t: t.to(torch.bfloat16) if t.is_floating_point() else t)(torch.as_tensor(a)))
    B = 1
    Sq = 2048
    Skv = 2048
    Hq = 32
    Hkv = 32
    Dh = 128
    bits = 2
    G = 64
    if G <= 0 or G >= Skv:
        G = max(1, Skv // 2)
    Skv = (Skv // G) * G
    ngk = Skv // G
    qmax = (1 << bits) - 1
    return {
        "q": _w((lambda *s: torch.randn(*s, dtype=torch.bfloat16) * 1.6)(B, Hq, Sq, Dh)),
        "qk": _w(torch.randint(0, qmax + 1, (B, Hkv, Skv, Dh)).to(torch.int32)),
        "qv": _w(torch.randint(0, qmax + 1, (B, Hkv, Skv, Dh)).to(torch.int32)),
        "k_scales": _w(torch.abs((lambda *s: torch.randn(*s, dtype=torch.bfloat16) * 1.6)(B, Hkv, ngk, Dh)) * 0.05 + 0.02),
        "k_zeros": _w((lambda *s: torch.randn(*s, dtype=torch.bfloat16) * 1.6)(B, Hkv, ngk, Dh) + float(qmax) / 2.0),
        "v_scales": _w(torch.abs((lambda *s: torch.randn(*s, dtype=torch.bfloat16) * 0.05)(B, Hkv, Skv, 1)) * 0.05 + 0.02),
        "v_zeros": _w((lambda *s: torch.randn(*s, dtype=torch.bfloat16) * 0.05)(B, Hkv, Skv, 1) + float(qmax) / 2.0),
    }

def reference(q, qk, qv, k_scales, k_zeros, v_scales, v_zeros):
    B, Hq, Sq, Dh = q.shape
    Hkv, Skv = qk.shape[1], qk.shape[2]
    ngk = k_scales.shape[2]
    G = Skv // ngk
    ks = (lambda x, n, axis: torch.repeat_interleave(x, n, dim=axis))(k_scales, G, axis=2)
    kz = (lambda x, n, axis: torch.repeat_interleave(x, n, dim=axis))(k_zeros, G, axis=2)
    k = ((lambda x, dt: x.to(dt))(qk, q.dtype) - kz) * ks
    v = ((lambda x, dt: x.to(dt))(qv, q.dtype) - v_zeros) * v_scales
    rep = Hq // Hkv
    if rep > 1:
        k = (lambda x, n, axis: torch.repeat_interleave(x, n, dim=axis))(k, rep, axis=1)
        v = (lambda x, n, axis: torch.repeat_interleave(x, n, dim=axis))(v, rep, axis=1)
    scale = float(Dh) ** -0.5
    logits = torch.einsum("bhqd,bhkd->bhqk", q, k) * scale
    p = _softmax(logits, axis=-1)
    o = torch.einsum("bhqk,bhkd->bhqd", p, v)
    return o
```

```asm
; @launch grid=(256,1,1) block=(256,1,1) lds=140800
.amdgcn_target "amdgcn-amd-amdhsa--gfx950"
.text
.globl standalone__kv_cache_quant_int4_int2_kv_with_per_channel_or_per_token_scales__prompt_kernel
.p2align 8
.type standalone__kv_cache_quant_int4_int2_kv_with_per_channel_or_per_token_scales__prompt_kernel,@function
standalone__kv_cache_quant_int4_int2_kv_with_per_channel_or_per_token_scales__prompt_kernel:
    s_cmp_ge_u32 s2, 256
    s_cbranch_scc1 L_end
    s_load_dwordx16 s[4:19], s[0:1], 0
    s_getpc_b64 s[28:29]
    v_lshlrev_b32 v56, 6, v0
    global_load_dword a246, v56, s[28:29]
    v_add_u32 v56, 0x4000, v56
    v_min_u32 v56, 21504, v56
    global_load_dword a247, v56, s[28:29]
    s_and_b32 s20, s2, 7
    s_lshl_b32 s20, s20, 2
    s_lshr_b32 s26, s2, 6
    s_add_u32 s20, s20, s26
    s_bfe_u32 s21, s2, 0x30003
    v_mov_b32 v248, 0
    v_mov_b32 v249, 0
    v_mov_b32 v250, 0
    v_mov_b32 v251, 0
    v_lshrrev_b32 v40, 5, v0
    v_and_b32 v41, 31, v0
    v_mfma_f32_32x32x16_bf16 a[112:127], v[248:251], v[248:251], 0
    v_lshlrev_b32 v1, 12, v40
    v_lshl_add_u32 v1, v41, 4, v1
    v_lshlrev_b32 v10, 4, v0
    v_add_u32 v11, 0x1000, v10
    v_lshrrev_b32 v42, 6, v0
    v_and_b32 v43, 63, v0
    v_readfirstlane_b32 s22, v42
    v_mfma_f32_32x32x16_bf16 a[96:111], v[248:251], v[248:251], 0
    v_lshlrev_b32 v3, 4, v43
    v_lshl_add_u32 v13, v42, 14, v3
    v_add_u32 v12, 0x1000, v13
    v_add_u32 v13, 0x3000, v13
    v_add_u32 v3, 34816, v3
    v_lshlrev_b32 v5, 4, v41
    v_add_u32 v5, 67840, v5
    v_mfma_f32_32x32x16_bf16 a[80:95], v[248:251], v[248:251], 0
    v_and_b32 v42, 1, v0
    v_mul_u32_u24 v4, 8256, v42
    v_lshl_add_u32 v4, v40, 8, v4
    v_bfe_u32 v42, v0, 1, 4
    v_lshl_add_u32 v4, v42, 4, v4
    v_add_u32 v4, 34816, v4
    v_mov_b32 v8, 0
    v_mfma_f32_32x32x16_bf16 a[64:79], v[248:251], v[248:251], 0
    v_bfe_u32 v40, v0, 3, 1
    v_mul_u32_u24 v2, 4352, v40
    v_bfe_u32 v40, v0, 5, 1
    v_mul_u32_u24 v14, 4352, v40
    v_lshl_add_u32 v14, v41, 3, v14
    v_mul_u32_u24 v41, 1088, v40
    v_add_u32 v2, v2, v41
    v_mfma_f32_32x32x16_bf16 a[48:63], v[248:251], v[248:251], 0
    v_and_b32 v40, 3, v0
    v_mul_u32_u24 v40, 272, v40
    v_add_u32 v2, v2, v40
    v_bfe_u32 v40, v0, 2, 1
    v_lshl_add_u32 v2, v40, 7, v2
    v_bfe_u32 v40, v0, 4, 1
    v_lshl_add_u32 v2, v40, 6, v2
    v_mfma_f32_32x32x16_bf16 a[32:47], v[248:251], v[248:251], 0
    s_mul_i32 s26, s22, 4352
    s_mov_b32 m0, s26
    s_lshr_b32 s26, s22, 1
    s_mul_i32 s26, s26, 8704
    s_and_b32 s27, s22, 1
    s_mul_i32 s27, s27, 2176
    s_add_u32 s26, s26, s27
    v_mfma_f32_32x32x16_bf16 a[16:31], v[248:251], v[248:251], 0
    s_add_u32 s26, s26, 123392
    v_add_u32 v15, s26, v2
    v_add_u32 v14, s26, v14
    v_bfe_u32 v40, v0, 4, 2
    v_lshlrev_b32 v6, 5, v40
    v_add_u32 v6, 68864, v6
    v_and_b32 v41, 15, v0
    v_mfma_f32_32x32x16_bf16 a[0:15], v[248:251], v[248:251], 0
    v_min_u32 v42, 6, v41
    v_lshlrev_b32 v42, 4, v42
    v_mul_u32_u24 v7, 112, v40
    v_add_u32 v7, v7, v42
    v_and_b32 v42, 1, v0
    v_mul_u32_u24 v60, 0xaaaa, v42
    v_add_u32 v60, 0x4444, v60
    v_lshl_or_b32 v60, v60, 16, v60
    v_add_u32 v7, 69120, v7
    v_lshrrev_b32 v40, 4, v0
    v_mul_u32_u24 v59, 1728, v40
    v_lshl_add_u32 v59, v41, 5, v59
    v_add_u32 v59, 67840, v59
    v_lshrrev_b32 v40, 3, v0
    v_mul_u32_u24 v57, 1728, v40
    v_and_b32 v40, 7, v0
    v_lshl_add_u32 v61, v42, 3, v57
    v_lshrrev_b32 v41, 1, v40
    v_mul_u32_u24 v41, 112, v41
    v_add_u32 v61, v61, v41
    v_lshl_add_u32 v57, v40, 5, v57
    v_add_u32 v57, 68864, v57
    v_add_u32 v61, 69120, v61
    v_mov_b32 v62, 0
    v_mov_b32 v63, 0
    s_mov_b32 s24, 0x47800000
    s_mov_b32 s32, 0x10001000
    s_mov_b32 s40, 0x788293ee
    s_mov_b32 s41, s40
    s_mov_b32 s42, 0xae0293ee
    s_mov_b32 s43, s42
    s_mov_b32 s44, 0xffff0000
    s_mov_b32 s23, 15
    s_lshl_b32 s26, s21, 12
    v_add_u32 v56, s26, v10
    s_lshl_b32 s26, s20, 13
    s_lshl_b32 s27, s20, 12
    s_lshl_b32 s33, s20, 20
    s_lshl_b32 s34, s20, 3
    s_add_u32 s34, s34, s21
    s_lshl_b32 s34, s34, 16
    ds_write_b64 v61, v[248:249] offset:96
    s_waitcnt lgkmcnt(0)
    s_add_u32 s10, s10, s26
    s_addc_u32 s11, s11, 0
    global_load_dwordx4 v[16:19], v10, s[10:11]
    s_add_u32 s12, s12, s26
    s_addc_u32 s13, s13, 0
    s_add_u32 s14, s14, s27
    s_addc_u32 s15, s15, 0
    s_add_u32 s16, s16, s27
    s_addc_u32 s17, s17, 0
    s_add_u32 s4, s4, s34
    s_addc_u32 s5, s5, 0
    s_add_u32 s28, s6, s33
    s_addc_u32 s29, s7, 0
    s_add_u32 s30, s8, s33
    s_addc_u32 s31, s9, 0
    s_add_u32 s36, s28, 0x8000
    s_addc_u32 s37, s29, 0
    s_add_u32 s38, s30, 0x8000
    s_addc_u32 s39, s31, 0
    s_add_u32 s6, s28, 0x10000
    s_addc_u32 s7, s29, 0
    s_add_u32 s8, s30, 0x10000
    s_addc_u32 s9, s31, 0
    s_add_u32 s18, s18, s34
    s_addc_u32 s19, s19, 0
    global_load_dwordx4 v[24:27], v10, s[12:13]
    global_load_dwordx4 v[32:35], v10, s[14:15]
    global_load_dwordx4 v[128:131], v1, s[28:29] offset:0 nt
    global_load_dwordx4 v[64:67], v12, s[4:5] offset:-4096 nt
    global_load_dwordx4 v[132:135], v1, s[28:29] offset:512 nt
    global_load_dwordx4 v[136:139], v1, s[28:29] offset:1024 nt
    global_load_dwordx4 v[68:71], v12, s[4:5] offset:-3072 nt
    global_load_dwordx4 v[140:143], v1, s[28:29] offset:1536 nt
    global_load_dwordx4 v[144:147], v1, s[28:29] offset:2048 nt
    global_load_dwordx4 v[72:75], v12, s[4:5] offset:-2048 nt
    s_mov_b64 vcc, 1
    s_cmp_eq_u32 s22, 0
    s_cbranch_scc1 L_stub0
    s_cmp_eq_u32 s22, 1
    s_cbranch_scc1 L_stub1
    s_cmp_eq_u32 s22, 2
    s_cbranch_scc1 L_stub2
L_back:
    s_waitcnt vmcnt(10)
    v_lshlrev_b32 v224, 16, v16
    v_and_b32 v225, s44, v16
    v_lshlrev_b32 v226, 16, v17
    v_and_b32 v227, s44, v17
    v_lshlrev_b32 v228, 16, v18
    global_load_dwordx4 v[148:151], v1, s[28:29] offset:2560 nt
    v_and_b32 v229, s44, v18
    v_lshlrev_b32 v230, 16, v19
    v_and_b32 v231, s44, v19
    v_pk_mul_f32 v[16:17], v[224:225], s[42:43]
    v_pk_mul_f32 v[18:19], v[226:227], s[42:43]
    v_pk_mul_f32 v[224:225], v[224:225], s[40:41]
    v_pk_mul_f32 v[226:227], v[226:227], s[40:41]
    ds_write_b128 v59, v[224:227] offset:0
    s_waitcnt vmcnt(10)
    v_lshlrev_b32 v232, 16, v24
    v_and_b32 v233, s44, v24
    v_lshlrev_b32 v234, 16, v25
    v_and_b32 v235, s44, v25
    v_pk_mul_f32 v[232:233], v[232:233], v[16:17]
    global_load_dwordx4 v[152:155], v1, s[28:29] offset:3072 nt
    v_pk_mul_f32 v[234:235], v[234:235], v[18:19]
    v_lshlrev_b32 v236, 16, v26
    v_and_b32 v237, s44, v26
    v_lshlrev_b32 v238, 16, v27
    v_and_b32 v239, s44, v27
    v_pk_mul_f32 v[16:17], v[228:229], s[42:43]
    v_pk_mul_f32 v[18:19], v[230:231], s[42:43]
    v_pk_mul_f32 v[228:229], v[228:229], s[40:41]
    v_pk_mul_f32 v[236:237], v[236:237], v[16:17]
    v_pk_mul_f32 v[230:231], v[230:231], s[40:41]
    v_pk_mul_f32 v[238:239], v[238:239], v[18:19]
    ds_write_b128 v59, v[232:235] offset:512
    ds_write_b128 v59, v[228:231] offset:16
    ds_write_b128 v59, v[236:239] offset:528
    global_load_dwordx4 v[76:79], v12, s[4:5] offset:-1024 nt
    s_waitcnt vmcnt(11)
    v_lshlrev_b32 v40, 16, v32
    v_and_b32 v41, s44, v32
    v_lshlrev_b32 v42, 16, v33
    v_and_b32 v43, s44, v33
    v_lshlrev_b32 v44, 16, v34
    v_and_b32 v45, s44, v34
    v_lshlrev_b32 v46, 16, v35
    v_and_b32 v47, s44, v35
    v_log_f32 v48, v40
    s_waitcnt lgkmcnt(0)
    s_barrier
    ds_read_b128 v[248:251], v5
    ds_read_b128 v[252:255], v5 offset:512
    v_log_f32 v49, v41
    v_log_f32 v50, v42
    v_log_f32 v51, v43
    v_log_f32 v52, v44
    v_log_f32 v53, v45
    v_log_f32 v54, v46
    global_load_dwordx4 v[156:159], v1, s[28:29] offset:3584 nt
    v_log_f32 v55, v47
    v_add_f32 v48, 0x42800000, v48
    v_add_f32 v49, 0x42800000, v49
    v_add_f32 v50, 0x42800000, v50
    v_add_f32 v51, 0x42800000, v51
    v_add_f32 v52, 0x42800000, v52
    v_add_f32 v53, 0x42800000, v53
    v_add_f32 v54, 0x42800000, v54
    v_add_f32 v55, 0x42800000, v55
    ds_write_b128 v57, v[48:51]
    ds_write_b128 v57, v[52:55] offset:16
    v_pk_fma_f32 v[62:63], v[224:225], v[232:233], v[62:63]
    v_min3_u32 v224, v40, v41, v42
    v_max3_u32 v225, v40, v41, v42
    v_min3_u32 v224, v43, v44, v224
    v_max3_u32 v225, v43, v44, v225
    global_load_dwordx4 v[36:39], v10, s[16:17]
    v_pk_fma_f32 v[62:63], v[226:227], v[234:235], v[62:63]
    v_rcp_f32 v48, v40
    v_rcp_f32 v49, v41
    v_rcp_f32 v50, v42
    v_rcp_f32 v51, v43
    v_rcp_f32 v52, v44
    s_waitcnt vmcnt(12) lgkmcnt(2)
    v_pk_fma_f32 v[128:129], v[128:129], v[248:249], v[252:253]
    v_pk_fma_f32 v[130:131], v[130:131], v[250:251], v[254:255]
    v_cvt_pk_bf16_f32 v128, v128, v129
    v_cvt_pk_bf16_f32 v130, v130, v131
    ds_write_addtid_b32 v128 offset:0
    ds_write_addtid_b32 v130 offset:1088
    v_rcp_f32 v53, v45
    v_rcp_f32 v54, v46
    v_rcp_f32 v55, v47
    v_min3_u32 v224, v45, v46, v224
    v_max3_u32 v225, v45, v46, v225
    global_load_dwordx4 v[20:23], v11, s[10:11]
    v_min_u32 v224, v47, v224
    v_max_u32 v225, v47, v225
    v_cvt_pk_bf16_f32 v232, v48, v49
    v_cvt_pk_bf16_f32 v234, v50, v51
    v_cvt_pk_bf16_f32 v233, v52, v53
    v_cvt_pk_bf16_f32 v235, v54, v55
    v_pk_fma_f32 v[62:63], v[228:229], v[236:237], v[62:63]
    v_lshlrev_b32 v40, 16, v232
    v_and_b32 v41, s44, v232
    v_lshlrev_b32 v42, 16, v234
    s_waitcnt vmcnt(12)
    v_mfma_f32_16x16x32_bf16 v[240:243], v[64:67], v[64:67], 0
    v_and_b32 v43, s44, v234
    v_lshlrev_b32 v44, 16, v233
    v_and_b32 v45, s44, v233
    v_lshlrev_b32 v46, 16, v235
    v_and_b32 v47, s44, v235
    v_pk_fma_f32 v[62:63], v[230:231], v[238:239], v[62:63]
    v_sub_f32 v40, v48, v40
    v_sub_f32 v41, v49, v41
    v_sub_f32 v42, v50, v42
    v_sub_f32 v43, v51, v43
    v_sub_f32 v44, v52, v44
    v_sub_f32 v45, v53, v45
    v_sub_f32 v46, v54, v46
    v_sub_f32 v47, v55, v47
    v_cvt_pk_bf16_f32 v236, v40, v41
    global_load_dwordx4 v[28:31], v11, s[12:13]
    v_cvt_pk_bf16_f32 v238, v42, v43
    v_cvt_pk_bf16_f32 v237, v44, v45
    v_cvt_pk_bf16_f32 v239, v46, v47
    v_add_u32 v40, s32, v64
    v_add_u32 v42, s32, v65
    v_add_u32 v41, s32, v66
    v_add_u32 v43, s32, v67
    ds_write2_b64 v14, v[40:41], v[42:43] offset0:0 offset1:136
    s_waitcnt vmcnt(12)
    v_pk_fma_f32 v[132:133], v[132:133], v[248:249], v[252:253]
    v_pk_fma_f32 v[134:135], v[134:135], v[250:251], v[254:255]
    v_cvt_pk_bf16_f32 v132, v132, v133
    v_cvt_pk_bf16_f32 v134, v134, v135
    ds_write_addtid_b32 v132 offset:272
    ds_write_addtid_b32 v134 offset:1360
    ds_write2_b64 v61, v[232:233], v[234:235] offset0:0 offset1:2
    global_load_dwordx4 v[192:195], v1, s[30:31] offset:0 nt
    ds_write2_b64 v61, v[236:237], v[238:239] offset0:4 offset1:6
    v_cmp_gt_u32 vcc, 0x37800000, v224
    s_nop 1
    v_cndmask_b32 v8, v8, 1, vcc
    v_cmp_lt_u32 vcc, 0x43800000, v225
    s_nop 1
    v_cndmask_b32 v8, v8, 1, vcc
    s_waitcnt vmcnt(12)
    v_pk_fma_f32 v[136:137], v[136:137], v[248:249], v[252:253]
    v_pk_fma_f32 v[138:139], v[138:139], v[250:251], v[254:255]
    v_cvt_pk_bf16_f32 v136, v136, v137
    v_cvt_pk_bf16_f32 v138, v138, v139
    ds_write_addtid_b32 v136 offset:544
    ds_write_addtid_b32 v138 offset:1632
    global_load_dwordx4 v[80:83], v12, s[4:5] offset:0 nt
    s_waitcnt vmcnt(12)
    v_mfma_f32_16x16x32_bf16 v[240:243], v[68:71], v[68:71], v[240:243]
    v_add_u32 v44, s32, v68
    v_add_u32 v46, s32, v69
    v_add_u32 v45, s32, v70
    v_add_u32 v47, s32, v71
    ds_write2_b64 v14, v[44:45], v[46:47] offset0:34 offset1:170
    global_load_dwordx4 v[196:199], v1, s[30:31] offset:512 nt
    s_waitcnt vmcnt(12)
    v_pk_fma_f32 v[140:141], v[140:141], v[248:249], v[252:253]
    v_pk_fma_f32 v[142:143], v[142:143], v[250:251], v[254:255]
    v_cvt_pk_bf16_f32 v140, v140, v141
    v_cvt_pk_bf16_f32 v142, v142, v143
    ds_write_addtid_b32 v140 offset:816
    ds_write_addtid_b32 v142 offset:1904
    global_load_dwordx4 v[200:203], v1, s[30:31] offset:1024 nt
    s_waitcnt vmcnt(12)
    v_pk_fma_f32 v[144:145], v[144:145], v[248:249], v[252:253]
    v_pk_fma_f32 v[146:147], v[146:147], v[250:251], v[254:255]
    v_cvt_pk_bf16_f32 v144, v144, v145
    v_cvt_pk_bf16_f32 v146, v146, v147
    ds_write_addtid_b32 v144 offset:2176
    ds_write_addtid_b32 v146 offset:3264
    global_load_dwordx4 v[84:87], v12, s[4:5] offset:1024 nt
    s_waitcnt vmcnt(12)
    v_mfma_f32_16x16x32_bf16 v[240:243], v[72:75], v[72:75], v[240:243]
    v_add_u32 v48, s32, v72
    v_add_u32 v50, s32, v73
    v_add_u32 v49, s32, v74
    v_add_u32 v51, s32, v75
    ds_write2_b64 v14, v[48:49], v[50:51] offset0:68 offset1:204
    global_load_dwordx4 v[204:207], v1, s[30:31] offset:1536 nt
    s_waitcnt vmcnt(12)
    v_pk_fma_f32 v[148:149], v[148:149], v[248:249], v[252:253]
    v_pk_fma_f32 v[150:151], v[150:151], v[250:251], v[254:255]
    v_cvt_pk_bf16_f32 v148, v148, v149
    v_cvt_pk_bf16_f32 v150, v150, v151
    ds_write_addtid_b32 v148 offset:2448
    ds_write_addtid_b32 v150 offset:3536
    global_load_dwordx4 v[208:211], v1, s[30:31] offset:2048 nt
    s_waitcnt vmcnt(12)
    v_pk_fma_f32 v[152:153], v[152:153], v[248:249], v[252:253]
    v_pk_fma_f32 v[154:155], v[154:155], v[250:251], v[254:255]
    v_cvt_pk_bf16_f32 v152, v152, v153
    v_cvt_pk_bf16_f32 v154, v154, v155
    ds_write_addtid_b32 v152 offset:2720
    ds_write_addtid_b32 v154 offset:3808
    global_load_dwordx4 v[88:91], v12, s[4:5] offset:2048 nt
    s_waitcnt vmcnt(12)
    v_mfma_f32_16x16x32_bf16 v[240:243], v[76:79], v[76:79], v[240:243]
    v_add_u32 v52, s32, v76
    v_add_u32 v54, s32, v77
    v_add_u32 v53, s32, v78
    v_add_u32 v55, s32, v79
    ds_write2_b64 v14, v[52:53], v[54:55] offset0:102 offset1:238
    ds_read_b128 a[144:147], v15 offset:0
    ds_read_b128 a[148:151], v15 offset:16
    ds_read_b128 a[152:155], v15 offset:32
    global_load_dwordx4 v[212:215], v1, s[30:31] offset:2560 nt
    ds_read_b128 a[156:159], v15 offset:48
    s_waitcnt vmcnt(12)
    v_pk_fma_f32 v[156:157], v[156:157], v[248:249], v[252:253]
    v_pk_fma_f32 v[158:159], v[158:159], v[250:251], v[254:255]
    v_cvt_pk_bf16_f32 v156, v156, v157
    v_cvt_pk_bf16_f32 v158, v158, v159
    ds_write_addtid_b32 v156 offset:2992
    ds_write_addtid_b32 v158 offset:4080
    ds_read_b128 v[248:251], v5 offset:1728
    ds_read_b128 v[252:255], v5 offset:2240
    global_load_dwordx4 v[216:219], v1, s[30:31] offset:3072 nt
    s_waitcnt lgkmcnt(2)
    s_barrier
    ds_read_b128 v[244:247], v6 offset:0
    ds_read_b128 a[208:211], v2 offset:0
    ds_read_b128 a[212:215], v2 offset:16
    ds_read_b128 a[216:219], v2 offset:32
    ds_read_b128 a[220:223], v2 offset:48
    ds_read_b128 v[16:19], v6 offset:16
    ds_read_b128 a[224:227], v2 offset:2176
    ds_read_b128 a[228:231], v2 offset:2192
    ds_read_b128 a[232:235], v2 offset:2208
    ds_read_b128 a[236:239], v2 offset:2224
    ds_read_b128 v[32:35], v6 offset:128
    ds_read_b128 v[128:131], v2 offset:8704
    ds_read_b128 v[132:135], v2 offset:8720
    ds_read_b128 v[136:139], v2 offset:8736
    ds_read_b128 v[140:143], v2 offset:8752
    ds_read_b128 v[24:27], v6 offset:144
    global_load_dwordx4 v[92:95], v12, s[4:5] offset:3072 nt
    ds_read_b128 v[144:147], v2 offset:10880
    ds_read_b128 v[148:151], v2 offset:10896
    ds_read_b128 v[152:155], v2 offset:10912
    ds_read_b128 v[156:159], v2 offset:10928
    s_waitcnt vmcnt(13)
    v_swap_b32 v37, v38
    ds_write2_b64 v61, v[36:37], v[38:39] offset0:8 offset1:10
    s_waitcnt lgkmcnt(15)
    v_mfma_f32_16x16x32_bf16 v[64:67], a[208:211], a[144:147], v[244:247]
    s_waitcnt vmcnt(12)
    v_lshlrev_b32 v224, 16, v20
    v_and_b32 v225, s44, v20
    v_mfma_f32_16x16x32_bf16 v[64:67], a[212:215], a[148:151], v[64:67]
    v_lshlrev_b32 v226, 16, v21
    v_and_b32 v227, s44, v21
    v_mfma_f32_16x16x32_bf16 v[64:67], a[216:219], a[152:155], v[64:67]
    v_lshlrev_b32 v228, 16, v22
    v_and_b32 v229, s44, v22
    v_mfma_f32_16x16x32_bf16 v[64:67], a[220:223], a[156:159], v[64:67]
    s_waitcnt lgkmcnt(14)
    v_lshlrev_b32 v230, 16, v23
    v_and_b32 v231, s44, v23
    v_mfma_f32_16x16x32_bf16 v[68:71], a[224:227], a[144:147], v[16:19]
    s_waitcnt lgkmcnt(13)
    global_load_dwordx4 v[220:223], v1, s[30:31] offset:3584 nt
    v_mfma_f32_16x16x32_bf16 v[68:71], a[228:231], a[148:151], v[68:71]
    s_waitcnt lgkmcnt(12)
    v_mfma_f32_16x16x32_bf16 v[68:71], a[232:235], a[152:155], v[68:71]
    s_waitcnt lgkmcnt(11)
    s_nop 1
    v_exp_f32 v64, v64
    v_mfma_f32_16x16x32_bf16 v[68:71], a[236:239], a[156:159], v[68:71]
    s_waitcnt lgkmcnt(9)
    v_exp_f32 v65, v65
    v_mfma_f32_16x16x32_bf16 v[72:75], v[128:131], a[144:147], v[32:35]
    s_waitcnt vmcnt(12) lgkmcnt(8)
    v_lshlrev_b32 v232, 16, v28
    v_and_b32 v233, s44, v28
    v_mfma_f32_16x16x32_bf16 v[72:75], v[132:135], a[148:151], v[72:75]
    s_waitcnt lgkmcnt(7)
    v_lshlrev_b32 v234, 16, v29
    v_and_b32 v235, s44, v29
    v_mfma_f32_16x16x32_bf16 v[72:75], v[136:139], a[152:155], v[72:75]
    s_waitcnt lgkmcnt(6)
    v_lshlrev_b32 v236, 16, v30
    v_and_b32 v237, s44, v30
    v_mfma_f32_16x16x32_bf16 v[72:75], v[140:143], a[156:159], v[72:75]
    s_waitcnt lgkmcnt(4)
    v_lshlrev_b32 v238, 16, v31
    global_load_dwordx4 v[160:163], v1, s[36:37] offset:0 nt
    v_mfma_f32_16x16x32_bf16 v[76:79], v[144:147], a[144:147], v[24:27]
    s_waitcnt lgkmcnt(3)
    v_and_b32 v239, s44, v31
    v_exp_f32 v66, v66
    v_mfma_f32_16x16x32_bf16 v[76:79], v[148:151], a[148:151], v[76:79]
    s_waitcnt lgkmcnt(2)
    v_exp_f32 v67, v67
    v_mfma_f32_16x16x32_bf16 v[76:79], v[152:155], a[152:155], v[76:79]
    s_waitcnt lgkmcnt(1)
    v_exp_f32 v68, v68
    v_mfma_f32_16x16x32_bf16 v[76:79], v[156:159], a[156:159], v[76:79]
    v_exp_f32 v69, v69
    v_exp_f32 v70, v70
    v_exp_f32 v71, v71
    v_pk_mul_f32 v[20:21], v[224:225], s[42:43]
    v_pk_mul_f32 v[224:225], v[224:225], s[40:41]
    v_pk_mul_f32 v[232:233], v[232:233], v[20:21]
    v_pk_mul_f32 v[22:23], v[226:227], s[42:43]
    v_pk_mul_f32 v[226:227], v[226:227], s[40:41]
    v_pk_mul_f32 v[234:235], v[234:235], v[22:23]
    global_load_dwordx4 v[96:99], v13, s[4:5] offset:-4096 nt
    ds_write_b128 v59, v[224:227] offset:27648
    ds_write_b128 v59, v[232:235] offset:28160
    v_pk_mul_f32 v[20:21], v[228:229], s[42:43]
    s_waitcnt vmcnt(12)
    v_mfma_f32_16x16x32_bf16 v[240:243], v[80:83], v[80:83], v[240:243]
    v_add_u32 v40, s32, v80
    v_add_u32 v42, s32, v81
    v_add_u32 v41, s32, v82
    v_add_u32 v43, s32, v83
    ds_write2_b64 v14, v[40:41], v[42:43] offset0:0 offset1:136
    v_pk_fma_f32 v[62:63], v[224:225], v[232:233], v[62:63]
    v_pk_mul_f32 v[228:229], v[228:229], s[40:41]
    v_pk_mul_f32 v[236:237], v[236:237], v[20:21]
    global_load_dwordx4 v[164:167], v1, s[36:37] offset:512 nt
    v_pk_mul_f32 v[22:23], v[230:231], s[42:43]
    v_pk_fma_f32 v[62:63], v[226:227], v[234:235], v[62:63]
    v_pk_mul_f32 v[230:231], v[230:231], s[40:41]
    v_pk_mul_f32 v[238:239], v[238:239], v[22:23]
    v_pk_fma_f32 v[62:63], v[228:229], v[236:237], v[62:63]
    ds_write_b128 v59, v[228:231] offset:27664
    ds_write_b128 v59, v[236:239] offset:28176
    v_pk_fma_f32 v[62:63], v[230:231], v[238:239], v[62:63]
    s_waitcnt vmcnt(12)
    v_fma_f32 v224, v196, s24, v192
    v_fma_f32 v228, v197, s24, v193
    v_fma_f32 v232, v198, s24, v194
    v_fma_f32 v236, v199, s24, v195
    v_exp_f32 v72, v72
    v_exp_f32 v73, v73
    v_exp_f32 v74, v74
    global_load_dwordx4 v[168:171], v1, s[36:37] offset:1024 nt
    v_exp_f32 v75, v75
    v_exp_f32 v76, v76
    v_exp_f32 v77, v77
    v_exp_f32 v78, v78
    v_exp_f32 v79, v79
    v_mov_b32 v20, 0
    v_mov_b32 v21, 0
    v_mov_b32 v22, 0
    v_mov_b32 v23, 0
    v_mov_b32 v28, 0
    v_mov_b32 v29, 0
    v_mov_b32 v30, 0
    v_mov_b32 v31, 0
    global_load_dwordx4 v[100:103], v13, s[4:5] offset:-3072 nt
    s_waitcnt vmcnt(12)
    v_mfma_f32_16x16x32_bf16 v[240:243], v[84:87], v[84:87], v[240:243]
    v_add_u32 v44, s32, v84
    v_add_u32 v46, s32, v85
    v_add_u32 v45, s32, v86
    v_add_u32 v47, s32, v87
    ds_write2_b64 v14, v[44:45], v[46:47] offset0:34 offset1:170
    global_load_dwordx4 v[172:175], v1, s[36:37] offset:1536 nt
    s_waitcnt vmcnt(12)
    v_fma_f32 v225, v204, s24, v200
    v_fma_f32 v229, v205, s24, v201
    v_fma_f32 v233, v206, s24, v202
    v_fma_f32 v237, v207, s24, v203
    global_load_dwordx4 v[176:179], v1, s[36:37] offset:2048 nt
    global_load_dwordx4 v[104:107], v13, s[4:5] offset:-2048 nt
    s_waitcnt vmcnt(12)
    v_mfma_f32_16x16x32_bf16 v[240:243], v[88:91], v[88:91], v[240:243]
    v_add_u32 v48, s32, v88
    v_add_u32 v50, s32, v89
    v_add_u32 v49, s32, v90
    v_add_u32 v51, s32, v91
    ds_write2_b64 v14, v[48:49], v[50:51] offset0:68 offset1:204
    global_load_dwordx4 v[180:183], v1, s[36:37] offset:2560 nt
    s_waitcnt vmcnt(12)
    v_fma_f32 v226, v212, s24, v208
    v_fma_f32 v230, v213, s24, v209
    v_fma_f32 v234, v214, s24, v210
    v_fma_f32 v238, v215, s24, v211
    global_load_dwordx4 v[184:187], v1, s[36:37] offset:3072 nt
    global_load_dwordx4 v[108:111], v13, s[4:5] offset:-1024 nt
    s_waitcnt vmcnt(12)
    v_mfma_f32_16x16x32_bf16 v[240:243], v[92:95], v[92:95], v[240:243]
    v_add_u32 v52, s32, v92
    v_add_u32 v54, s32, v93
    v_add_u32 v53, s32, v94
    v_add_u32 v55, s32, v95
    ds_write2_b64 v14, v[52:53], v[54:55] offset0:102 offset1:238
    ds_read_b128 a[160:163], v15 offset:0
    ds_read_b128 a[164:167], v15 offset:16
    ds_read_b128 a[168:171], v15 offset:32
    ds_read_b128 a[172:175], v15 offset:48
    global_load_dwordx4 v[188:191], v1, s[36:37] offset:3584 nt
    s_waitcnt vmcnt(12)
    v_fma_f32 v227, v220, s24, v216
    v_fma_f32 v231, v221, s24, v217
    v_fma_f32 v235, v222, s24, v218
    v_fma_f32 v239, v223, s24, v219
    ds_write_b128 v4, v[224:227] offset:0
    s_waitcnt lgkmcnt(4)
    v_mfma_f32_16x16x32_bf16 v[80:83], a[208:211], a[160:163], v[244:247]
    s_waitcnt lgkmcnt(3)
    ds_write_b128 v4, v[228:231] offset:2048
    v_mfma_f32_16x16x32_bf16 v[80:83], a[212:215], a[164:167], v[80:83]
    s_waitcnt lgkmcnt(3)
    global_load_dwordx4 v[112:115], v13, s[4:5] offset:0 nt
    ds_write_b128 v4, v[232:235] offset:4096
    v_mfma_f32_16x16x32_bf16 v[80:83], a[216:219], a[168:171], v[80:83]
    s_waitcnt lgkmcnt(3)
    ds_write_b128 v4, v[236:239] offset:6144
    v_mfma_f32_16x16x32_bf16 v[80:83], a[220:223], a[172:175], v[80:83]
    v_mfma_f32_16x16x32_bf16 v[84:87], a[224:227], a[160:163], v[16:19]
    v_mfma_f32_16x16x32_bf16 v[84:87], a[228:231], a[164:167], v[84:87]
    v_mfma_f32_16x16x32_bf16 v[84:87], a[232:235], a[168:171], v[84:87]
    s_nop 4
    v_exp_f32 v80, v80
    v_mfma_f32_16x16x32_bf16 v[84:87], a[236:239], a[172:175], v[84:87]
    global_load_dwordx4 v[116:119], v13, s[4:5] offset:1024 nt
    v_exp_f32 v81, v81
    v_mfma_f32_16x16x32_bf16 v[88:91], v[128:131], a[160:163], v[32:35]
    v_exp_f32 v82, v82
    v_mfma_f32_16x16x32_bf16 v[88:91], v[132:135], a[164:167], v[88:91]
    s_waitcnt vmcnt(12)
    v_add_u32 v40, s32, v96
    v_add_u32 v42, s32, v97
    v_mfma_f32_16x16x32_bf16 v[88:91], v[136:139], a[168:171], v[88:91]
    v_add_u32 v41, s32, v98
    v_add_u32 v43, s32, v99
    v_mfma_f32_16x16x32_bf16 v[88:91], v[140:143], a[172:175], v[88:91]
    ds_write2_b64 v14, v[40:41], v[42:43] offset0:0 offset1:136
    v_mfma_f32_16x16x32_bf16 v[92:95], v[144:147], a[160:163], v[24:27]
    v_exp_f32 v83, v83
    v_mfma_f32_16x16x32_bf16 v[92:95], v[148:151], a[164:167], v[92:95]
    v_exp_f32 v84, v84
    v_mfma_f32_16x16x32_bf16 v[92:95], v[152:155], a[168:171], v[92:95]
    global_load_dwordx4 v[120:123], v13, s[4:5] offset:2048 nt
    v_exp_f32 v85, v85
    v_mfma_f32_16x16x32_bf16 v[92:95], v[156:159], a[172:175], v[92:95]
    v_exp_f32 v86, v86
    v_mfma_f32_16x16x32_bf16 v[240:243], v[96:99], v[96:99], v[240:243]
    v_exp_f32 v87, v87
    v_exp_f32 v88, v88
    v_exp_f32 v89, v89
    v_pk_fma_f32 v[160:161], v[160:161], v[248:249], v[252:253]
    v_pk_fma_f32 v[162:163], v[162:163], v[250:251], v[254:255]
    s_waitcnt vmcnt(12)
    v_pk_fma_f32 v[164:165], v[164:165], v[248:249], v[252:253]
    v_pk_fma_f32 v[166:167], v[166:167], v[250:251], v[254:255]
    v_cvt_pk_bf16_f32 v160, v160, v161
    v_cvt_pk_bf16_f32 v162, v162, v163
    v_cvt_pk_bf16_f32 v164, v164, v165
    v_cvt_pk_bf16_f32 v166, v166, v167
    ds_write_addtid_b32 v160 offset:17408
    ds_write_addtid_b32 v162 offset:18496
    ds_write_addtid_b32 v164 offset:17680
    ds_write_addtid_b32 v166 offset:18768
    v_exp_f32 v90, v90
    global_load_dwordx4 v[124:127], v13, s[4:5] offset:3072 nt
    v_exp_f32 v91, v91
    v_exp_f32 v92, v92
    s_waitcnt vmcnt(12)
    v_pk_fma_f32 v[168:169], v[168:169], v[248:249], v[252:253]
    v_pk_fma_f32 v[170:171], v[170:171], v[250:251], v[254:255]
    v_cvt_pk_bf16_f32 v168, v168, v169
    v_cvt_pk_bf16_f32 v170, v170, v171
    ds_write_addtid_b32 v168 offset:17952
    ds_write_addtid_b32 v170 offset:19040
    v_exp_f32 v93, v93
    v_exp_f32 v94, v94
    v_exp_f32 v95, v95
    global_load_dwordx4 v[192:195], v1, s[38:39] offset:0 nt
    s_waitcnt vmcnt(12)
    v_mfma_f32_16x16x32_bf16 v[240:243], v[100:103], v[100:103], v[240:243]
    v_add_u32 v44, s32, v100
    v_add_u32 v46, s32, v101
    v_add_u32 v45, s32, v102
    v_add_u32 v47, s32, v103
    ds_write2_b64 v14, v[44:45], v[46:47] offset0:34 offset1:170
    global_load_dwordx4 v[196:199], v1, s[38:39] offset:512 nt
    s_waitcnt vmcnt(12)
    v_pk_fma_f32 v[172:173], v[172:173], v[248:249], v[252:253]
    v_pk_fma_f32 v[174:175], v[174:175], v[250:251], v[254:255]
    v_cvt_pk_bf16_f32 v172, v172, v173
    v_cvt_pk_bf16_f32 v174, v174, v175
    ds_write_addtid_b32 v172 offset:18224
    ds_write_addtid_b32 v174 offset:19312
    global_load_dwordx4 v[200:203], v1, s[38:39] offset:1024 nt
    s_waitcnt vmcnt(12)
    v_pk_fma_f32 v[176:177], v[176:177], v[248:249], v[252:253]
    v_pk_fma_f32 v[178:179], v[178:179], v[250:251], v[254:255]
    v_cvt_pk_bf16_f32 v176, v176, v177
    v_cvt_pk_bf16_f32 v178, v178, v179
    ds_write_addtid_b32 v176 offset:19584
    ds_write_addtid_b32 v178 offset:20672
    global_load_dwordx4 v[204:207], v1, s[38:39] offset:1536 nt
    s_waitcnt vmcnt(12)
    v_mfma_f32_16x16x32_bf16 v[240:243], v[104:107], v[104:107], v[240:243]
    v_add_u32 v48, s32, v104
    v_add_u32 v50, s32, v105
    v_add_u32 v49, s32, v106
    v_add_u32 v51, s32, v107
    ds_write2_b64 v14, v[48:49], v[50:51] offset0:68 offset1:204
    global_load_dwordx4 v[208:211], v1, s[38:39] offset:2048 nt
    s_waitcnt vmcnt(12)
    v_pk_fma_f32 v[180:181], v[180:181], v[248:249], v[252:253]
    v_pk_fma_f32 v[182:183], v[182:183], v[250:251], v[254:255]
    v_cvt_pk_bf16_f32 v180, v180, v181
    v_cvt_pk_bf16_f32 v182, v182, v183
    ds_write_addtid_b32 v180 offset:19856
    ds_write_addtid_b32 v182 offset:20944
    global_load_dwordx4 v[212:215], v1, s[38:39] offset:2560 nt
    s_waitcnt vmcnt(12)
    v_pk_fma_f32 v[184:185], v[184:185], v[248:249], v[252:253]
    v_pk_fma_f32 v[186:187], v[186:187], v[250:251], v[254:255]
    v_cvt_pk_bf16_f32 v184, v184, v185
    v_cvt_pk_bf16_f32 v186, v186, v187
    ds_write_addtid_b32 v184 offset:20128
    ds_write_addtid_b32 v186 offset:21216
    global_load_dwordx4 v[216:219], v1, s[38:39] offset:3072 nt
    s_waitcnt vmcnt(12)
    v_mfma_f32_16x16x32_bf16 v[240:243], v[108:111], v[108:111], v[240:243]
    v_add_u32 v52, s32, v108
    v_add_u32 v54, s32, v109
    v_add_u32 v53, s32, v110
    v_add_u32 v55, s32, v111
    ds_write2_b64 v14, v[52:53], v[54:55] offset0:102 offset1:238
    ds_read_b128 a[176:179], v15 offset:0
    ds_read_b128 a[180:183], v15 offset:16
    ds_read_b128 a[184:187], v15 offset:32
    ds_read_b128 a[188:191], v15 offset:48
    global_load_dwordx4 v[220:223], v1, s[38:39] offset:3584 nt
    s_waitcnt vmcnt(12)
    v_pk_fma_f32 v[188:189], v[188:189], v[248:249], v[252:253]
    v_pk_fma_f32 v[190:191], v[190:191], v[250:251], v[254:255]
    v_cvt_pk_bf16_f32 v188, v188, v189
    v_cvt_pk_bf16_f32 v190, v190, v191
    ds_write_addtid_b32 v188 offset:20400
    ds_write_addtid_b32 v190 offset:21488
    s_waitcnt lgkmcnt(5)
    v_mfma_f32_16x16x32_bf16 v[96:99], a[208:211], a[176:179], v[244:247]
    s_waitcnt lgkmcnt(4)
    v_mfma_f32_16x16x32_bf16 v[96:99], a[212:215], a[180:183], v[96:99]
    s_waitcnt lgkmcnt(3)
    v_mfma_f32_16x16x32_bf16 v[96:99], a[216:219], a[184:187], v[96:99]
    s_waitcnt lgkmcnt(2)
    v_mfma_f32_16x16x32_bf16 v[96:99], a[220:223], a[188:191], v[96:99]
    s_waitcnt lgkmcnt(0)
    global_load_dwordx4 v[160:163], v1, s[6:7] offset:0 nt
    s_barrier
    v_mfma_f32_16x16x32_bf16 v[100:103], a[224:227], a[176:179], v[16:19]
    s_waitcnt vmcnt(12)
    v_add_u32 v40, s32, v112
    v_add_u32 v42, s32, v113
    v_mfma_f32_16x16x32_bf16 v[100:103], a[228:231], a[180:183], v[100:103]
    v_add_u32 v41, s32, v114
    v_add_u32 v43, s32, v115
    v_mfma_f32_16x16x32_bf16 v[100:103], a[232:235], a[184:187], v[100:103]
    ds_write2_b64 v14, v[40:41], v[42:43] offset0:0 offset1:136
    v_mfma_f32_16x16x32_bf16 v[100:103], a[236:239], a[188:191], v[100:103]
    v_exp_f32 v96, v96
    v_mfma_f32_16x16x32_bf16 v[104:107], v[128:131], a[176:179], v[32:35]
    v_exp_f32 v97, v97
    v_mfma_f32_16x16x32_bf16 v[104:107], v[132:135], a[180:183], v[104:107]
    global_load_dwordx4 v[164:167], v1, s[6:7] offset:512 nt
    v_exp_f32 v98, v98
    v_mfma_f32_16x16x32_bf16 v[104:107], v[136:139], a[184:187], v[104:107]
    v_exp_f32 v99, v99
    v_mfma_f32_16x16x32_bf16 v[104:107], v[140:143], a[188:191], v[104:107]
    s_waitcnt vmcnt(12)
    v_add_u32 v44, s32, v116
    v_add_u32 v46, s32, v117
    v_mfma_f32_16x16x32_bf16 v[108:111], v[144:147], a[176:179], v[24:27]
    v_add_u32 v45, s32, v118
    v_add_u32 v47, s32, v119
    v_mfma_f32_16x16x32_bf16 v[108:111], v[148:151], a[180:183], v[108:111]
    ds_write2_b64 v14, v[44:45], v[46:47] offset0:34 offset1:170
    v_mfma_f32_16x16x32_bf16 v[108:111], v[152:155], a[184:187], v[108:111]
    v_exp_f32 v100, v100
    v_mfma_f32_16x16x32_bf16 v[108:111], v[156:159], a[188:191], v[108:111]
    v_exp_f32 v101, v101
    v_mfma_f32_16x16x32_bf16 v[240:243], v[112:115], v[112:115], v[240:243]
    global_load_dwordx4 v[168:171], v1, s[6:7] offset:1024 nt
    v_exp_f32 v102, v102
    v_mfma_f32_16x16x32_bf16 v[240:243], v[116:119], v[116:119], v[240:243]
    s_waitcnt vmcnt(12)
    v_exp_f32 v103, v103
    v_exp_f32 v104, v104
    v_mfma_f32_16x16x32_bf16 v[240:243], v[120:123], v[120:123], v[240:243]
    v_add_u32 v48, s32, v120
    v_add_u32 v50, s32, v121
    v_add_u32 v49, s32, v122
    v_add_u32 v51, s32, v123
    ds_write2_b64 v14, v[48:49], v[50:51] offset0:68 offset1:204
    v_exp_f32 v105, v105
    v_exp_f32 v106, v106
    v_exp_f32 v107, v107
    v_exp_f32 v108, v108
    global_load_dwordx4 v[172:175], v1, s[6:7] offset:1536 nt
    v_exp_f32 v109, v109
    v_exp_f32 v110, v110
    v_exp_f32 v111, v111
    s_waitcnt vmcnt(12)
    v_mfma_f32_16x16x32_bf16 v[240:243], v[124:127], v[124:127], v[240:243]
    v_add_u32 v52, s32, v124
    v_add_u32 v54, s32, v125
    v_add_u32 v53, s32, v126
    v_add_u32 v55, s32, v127
    ds_write2_b64 v14, v[52:53], v[54:55] offset0:102 offset1:238
    ds_read_b128 a[192:195], v15 offset:0
    ds_read_b128 a[196:199], v15 offset:16
    ds_read_b128 a[200:203], v15 offset:32
    ds_read_b128 a[204:207], v15 offset:48
    v_fma_f32 v62, v240, 0, v62
    v_fma_f32 v62, v241, 0, v62
    v_fma_f32 v62, v242, 0, v62
    global_load_dwordx4 v[176:179], v1, s[6:7] offset:2048 nt
    v_fma_f32 v62, v243, 0, v62
    ds_read_b128 v[240:243], v6 offset:1728
    v_add_f32 v62, v62, v63
    v_fma_f32 v62, v62, 0, 0
    v_cmp_u_f32 vcc, v62, v62
    s_nop 1
    v_cndmask_b32 v8, v8, 1, vcc
    s_waitcnt lgkmcnt(4)
    v_mfma_f32_16x16x32_bf16 v[112:115], a[208:211], a[192:195], v[244:247]
    s_waitcnt lgkmcnt(3)
    ds_read_b128 a[208:211], v2 offset:17408
    v_mfma_f32_16x16x32_bf16 v[112:115], a[212:215], a[196:199], v[112:115]
    s_waitcnt lgkmcnt(3)
    ds_read_b128 a[212:215], v2 offset:17424
    v_mfma_f32_16x16x32_bf16 v[112:115], a[216:219], a[200:203], v[112:115]
    s_waitcnt lgkmcnt(3)
    global_load_dwordx4 v[180:183], v1, s[6:7] offset:2560 nt
    ds_read_b128 a[216:219], v2 offset:17440
    v_mfma_f32_16x16x32_bf16 v[112:115], a[220:223], a[204:207], v[112:115]
    ds_read_b128 a[220:223], v2 offset:17456
    v_mfma_f32_16x16x32_bf16 v[116:119], a[224:227], a[192:195], v[16:19]
    s_nop 2
    v_mov_b32 v16, 0
    v_mov_b32 v17, 0
    v_mfma_f32_16x16x32_bf16 v[116:119], a[228:231], a[196:199], v[116:119]
    v_mov_b32 v18, 0
    v_mov_b32 v19, 0
    v_mfma_f32_16x16x32_bf16 v[116:119], a[232:235], a[200:203], v[116:119]
    v_exp_f32 v112, v112
    v_mfma_f32_16x16x32_bf16 v[116:119], a[236:239], a[204:207], v[116:119]
    v_exp_f32 v113, v113
    v_mfma_f32_16x16x32_bf16 v[120:123], v[128:131], a[192:195], v[32:35]
    v_exp_f32 v114, v114
    v_mfma_f32_16x16x32_bf16 v[120:123], v[132:135], a[196:199], v[120:123]
    v_exp_f32 v115, v115
    v_mfma_f32_16x16x32_bf16 v[120:123], v[136:139], a[200:203], v[120:123]
    global_load_dwordx4 v[184:187], v1, s[6:7] offset:3072 nt
    s_nop 0
    v_exp_f32 v116, v116
    v_mfma_f32_16x16x32_bf16 v[120:123], v[140:143], a[204:207], v[120:123]
    v_exp_f32 v117, v117
    v_mfma_f32_16x16x32_bf16 v[124:127], v[144:147], a[192:195], v[24:27]
    v_exp_f32 v118, v118
    v_mfma_f32_16x16x32_bf16 v[124:127], v[148:151], a[196:199], v[124:127]
    v_exp_f32 v119, v119
    v_mfma_f32_16x16x32_bf16 v[124:127], v[152:155], a[200:203], v[124:127]
    v_mov_b32 v24, 0
    s_nop 0
    v_exp_f32 v120, v120
    v_mfma_f32_16x16x32_bf16 v[124:127], v[156:159], a[204:207], v[124:127]
    v_exp_f32 v121, v121
    v_exp_f32 v122, v122
    v_exp_f32 v123, v123
    v_mov_b32 v25, 0
    v_mov_b32 v26, 0
    global_load_dwordx4 v[188:191], v1, s[6:7] offset:3584 nt
    v_mov_b32 v27, 0
    v_cvt_pk_bf16_f32 v128, v64, v65
    v_exp_f32 v124, v124
    v_exp_f32 v125, v125
    v_exp_f32 v126, v126
    v_exp_f32 v127, v127
    v_cvt_pk_bf16_f32 v129, v66, v67
    s_mov_b32 s45, 4
    s_lshl_b32 s26, s21, 12
    v_lshlrev_b32 v52, 4, v0
    v_add_u32 v52, s26, v52
    s_add_u32 s46, s28, 0xf8000
    s_addc_u32 s47, s29, 0
    s_waitcnt lgkmcnt(3)
    s_mov_b64 vcc, 0
    s_branch L_loop
.p2align 12
L_stub0:
    s_branch L_back
    s_nop 0
L_loop:
    v_mfma_f32_16x16x32_bf16 v[64:67], a[208:211], a[144:147], v[240:243]
    s_waitcnt vmcnt(14) lgkmcnt(2)
    v_fma_f32 v224, v196, s24, v192
    v_fma_f32 v228, v197, s24, v193
    v_mfma_f32_16x16x32_bf16 v[64:67], a[212:215], a[148:151], v[64:67]
    s_waitcnt lgkmcnt(1)
    ds_read_b128 a[224:227], v2 offset:19584
    v_cvt_pk_bf16_f32 v136, v80, v81
    v_mfma_f32_16x16x32_bf16 v[64:67], a[216:219], a[152:155], v[64:67]
    s_waitcnt lgkmcnt(1)
    v_fma_f32 v232, v198, s24, v194
    v_fma_f32 v236, v199, s24, v195
    v_mfma_f32_16x16x32_bf16 v[64:67], a[220:223], a[156:159], v[64:67]
    s_add_u32 s6, s6, 0x8000
    ds_read_b128 v[244:247], v6 offset:1744
    v_cvt_pk_bf16_f32 v137, v82, v83
    v_mfma_f32_16x16x32_bf16 v[80:83], a[208:211], a[160:163], v[240:243]
    s_waitcnt vmcnt(12)
    v_fma_f32 v225, v204, s24, v200
    v_fma_f32 v229, v205, s24, v201
    v_mfma_f32_16x16x32_bf16 v[80:83], a[212:215], a[164:167], v[80:83]
    s_addc_u32 s7, s7, 0
    ds_read_b128 a[228:231], v2 offset:19600
    v_cvt_pk_bf16_f32 v144, v96, v97
    v_mfma_f32_16x16x32_bf16 v[80:83], a[216:219], a[168:171], v[80:83]
    v_fma_f32 v233, v206, s24, v202
    v_fma_f32 v237, v207, s24, v203
    v_mfma_f32_16x16x32_bf16 v[80:83], a[220:223], a[172:175], v[80:83]
    ds_read_b128 a[232:235], v2 offset:19616
    v_cvt_pk_bf16_f32 v145, v98, v99
    v_mfma_f32_16x16x32_bf16 v[96:99], a[208:211], a[176:179], v[240:243]
    v_exp_f32 v64, v64
    v_mfma_f32_16x16x32_bf16 v[96:99], a[212:215], a[180:183], v[96:99]
    ds_read_b128 a[236:239], v2 offset:19632
    v_cvt_pk_bf16_f32 v152, v112, v113
    v_mfma_f32_16x16x32_bf16 v[96:99], a[216:219], a[184:187], v[96:99]
    v_exp_f32 v65, v65
    v_mfma_f32_16x16x32_bf16 v[96:99], a[220:223], a[188:191], v[96:99]
    global_load_dwordx4 v[192:195], v1, s[8:9] offset:0 nt
    v_cvt_pk_bf16_f32 v153, v114, v115
    v_mfma_f32_16x16x32_bf16 v[112:115], a[208:211], a[192:195], v[240:243]
    v_exp_f32 v66, v66
    v_mfma_f32_16x16x32_bf16 v[112:115], a[212:215], a[196:199], v[112:115]
    global_load_dwordx4 v[196:199], v1, s[8:9] offset:512 nt
    v_cvt_pk_bf16_f32 v130, v68, v69
    v_mfma_f32_16x16x32_bf16 v[112:115], a[216:219], a[200:203], v[112:115]
    v_exp_f32 v67, v67
    v_mfma_f32_16x16x32_bf16 v[112:115], a[220:223], a[204:207], v[112:115]
    s_waitcnt lgkmcnt(3)
    global_load_dwordx4 v[200:203], v1, s[8:9] offset:1024 nt
    v_cvt_pk_bf16_f32 v131, v70, v71
    v_mfma_f32_16x16x32_bf16 v[68:71], a[224:227], a[144:147], v[244:247]
    s_waitcnt lgkmcnt(2)
    v_exp_f32 v80, v80
    v_mfma_f32_16x16x32_bf16 v[68:71], a[228:231], a[148:151], v[68:71]
    s_waitcnt lgkmcnt(1)
    global_load_dwordx4 v[204:207], v1, s[8:9] offset:1536 nt
    v_cvt_pk_bf16_f32 v138, v84, v85
    v_mfma_f32_16x16x32_bf16 v[68:71], a[232:235], a[152:155], v[68:71]
    s_waitcnt lgkmcnt(0)
    v_exp_f32 v81, v81
    v_mfma_f32_16x16x32_bf16 v[68:71], a[236:239], a[156:159], v[68:71]
    ds_read_b128 a[208:211], v2 offset:26112
    v_cvt_pk_bf16_f32 v139, v86, v87
    v_mfma_f32_16x16x32_bf16 v[84:87], a[224:227], a[160:163], v[244:247]
    v_exp_f32 v82, v82
    v_mfma_f32_16x16x32_bf16 v[84:87], a[228:231], a[164:167], v[84:87]
    ds_read_b128 v[240:243], v6 offset:1856
    v_cvt_pk_bf16_f32 v146, v100, v101
    v_mfma_f32_16x16x32_bf16 v[84:87], a[232:235], a[168:171], v[84:87]
    v_exp_f32 v83, v83
    v_mfma_f32_16x16x32_bf16 v[84:87], a[236:239], a[172:175], v[84:87]
    ds_read_b128 a[212:215], v2 offset:26128
    v_cvt_pk_bf16_f32 v147, v102, v103
    v_mfma_f32_16x16x32_bf16 v[100:103], a[224:227], a[176:179], v[244:247]
    s_waitcnt vmcnt(14)
    v_fma_f32 v226, v212, s24, v208
    v_fma_f32 v230, v213, s24, v209
    v_mfma_f32_16x16x32_bf16 v[100:103], a[228:231], a[180:183], v[100:103]
    ds_read_b128 a[216:219], v2 offset:26144
    v_cvt_pk_bf16_f32 v154, v116, v117
    v_mfma_f32_16x16x32_bf16 v[100:103], a[232:235], a[184:187], v[100:103]
    v_fma_f32 v234, v214, s24, v210
    v_fma_f32 v238, v215, s24, v211
    v_mfma_f32_16x16x32_bf16 v[100:103], a[236:239], a[188:191], v[100:103]
    ds_read_b128 a[220:223], v2 offset:26160
    v_cvt_pk_bf16_f32 v155, v118, v119
    v_mfma_f32_16x16x32_bf16 v[116:119], a[224:227], a[192:195], v[244:247]
    v_exp_f32 v96, v96
    v_mfma_f32_16x16x32_bf16 v[116:119], a[228:231], a[196:199], v[116:119]
    global_load_dwordx4 v[208:211], v1, s[8:9] offset:2048 nt
    v_cvt_pk_bf16_f32 v132, v72, v73
    v_mfma_f32_16x16x32_bf16 v[116:119], a[232:235], a[200:203], v[116:119]
    v_exp_f32 v97, v97
    v_mfma_f32_16x16x32_bf16 v[116:119], a[236:239], a[204:207], v[116:119]
    s_waitcnt lgkmcnt(3)
    global_load_dwordx4 v[212:215], v1, s[8:9] offset:2560 nt
    v_cvt_pk_bf16_f32 v133, v74, v75
    v_mfma_f32_16x16x32_bf16 v[72:75], a[208:211], a[144:147], v[240:243]
    s_waitcnt lgkmcnt(2)
    v_exp_f32 v98, v98
    v_mfma_f32_16x16x32_bf16 v[72:75], a[212:215], a[148:151], v[72:75]
    s_waitcnt lgkmcnt(1)
    ds_read_b128 a[224:227], v2 offset:28288
    v_cvt_pk_bf16_f32 v140, v88, v89
    v_mfma_f32_16x16x32_bf16 v[72:75], a[216:219], a[152:155], v[72:75]
    s_waitcnt lgkmcnt(1)
    v_exp_f32 v99, v99
    v_mfma_f32_16x16x32_bf16 v[72:75], a[220:223], a[156:159], v[72:75]
    ds_read_b128 v[244:247], v6 offset:1872
    v_cvt_pk_bf16_f32 v141, v90, v91
    v_mfma_f32_16x16x32_bf16 v[88:91], a[208:211], a[160:163], v[240:243]
    v_exp_f32 v112, v112
    v_mfma_f32_16x16x32_bf16 v[88:91], a[212:215], a[164:167], v[88:91]
    ds_read_b128 a[228:231], v2 offset:28304
    v_cvt_pk_bf16_f32 v148, v104, v105
    v_mfma_f32_16x16x32_bf16 v[88:91], a[216:219], a[168:171], v[88:91]
    v_exp_f32 v113, v113
    v_mfma_f32_16x16x32_bf16 v[88:91], a[220:223], a[172:175], v[88:91]
    ds_read_b128 a[232:235], v2 offset:28320
    v_cvt_pk_bf16_f32 v149, v106, v107
    v_mfma_f32_16x16x32_bf16 v[104:107], a[208:211], a[176:179], v[240:243]
    s_waitcnt vmcnt(14)
    v_fma_f32 v227, v220, s24, v216
    v_fma_f32 v231, v221, s24, v217
    v_mfma_f32_16x16x32_bf16 v[104:107], a[212:215], a[180:183], v[104:107]
    ds_read_b128 a[236:239], v2 offset:28336
    v_cvt_pk_bf16_f32 v156, v120, v121
    v_mfma_f32_16x16x32_bf16 v[104:107], a[216:219], a[184:187], v[104:107]
    v_fma_f32 v235, v222, s24, v218
    v_fma_f32 v239, v223, s24, v219
    v_mfma_f32_16x16x32_bf16 v[104:107], a[220:223], a[188:191], v[104:107]
    global_load_dwordx4 v[216:219], v1, s[8:9] offset:3072 nt
    v_cvt_pk_bf16_f32 v157, v122, v123
    v_mfma_f32_16x16x32_bf16 v[120:123], a[208:211], a[192:195], v[240:243]
    v_exp_f32 v114, v114
    v_mfma_f32_16x16x32_bf16 v[120:123], a[212:215], a[196:199], v[120:123]
    global_load_dwordx4 v[220:223], v1, s[8:9] offset:3584 nt
    v_cvt_pk_bf16_f32 v134, v76, v77
    v_mfma_f32_16x16x32_bf16 v[120:123], a[216:219], a[200:203], v[120:123]
    v_exp_f32 v115, v115
    v_mfma_f32_16x16x32_bf16 v[120:123], a[220:223], a[204:207], v[120:123]
    s_waitcnt lgkmcnt(3)
    ds_read_b128 v[248:251], v5 offset:3456
    v_cvt_pk_bf16_f32 v135, v78, v79
    v_mfma_f32_16x16x32_bf16 v[76:79], a[224:227], a[144:147], v[244:247]
    s_waitcnt lgkmcnt(3)
    v_exp_f32 v68, v68
    v_mfma_f32_16x16x32_bf16 v[76:79], a[228:231], a[148:151], v[76:79]
    s_waitcnt lgkmcnt(2)
    ds_read_b128 v[252:255], v5 offset:3968
    v_cvt_pk_bf16_f32 v142, v92, v93
    v_mfma_f32_16x16x32_bf16 v[76:79], a[232:235], a[152:155], v[76:79]
    s_waitcnt lgkmcnt(2)
    v_exp_f32 v69, v69
    v_mfma_f32_16x16x32_bf16 v[76:79], a[236:239], a[156:159], v[76:79]
    s_add_u32 s8, s8, 0x8000
    ds_read_b128 a[240:243], v3 offset:0
    v_cvt_pk_bf16_f32 v143, v94, v95
    v_mfma_f32_16x16x32_bf16 v[92:95], a[224:227], a[160:163], v[244:247]
    s_addc_u32 s9, s9, 0
    v_exp_f32 v70, v70
    v_mfma_f32_16x16x32_bf16 v[92:95], a[228:231], a[164:167], v[92:95]
    ds_read_b128 a[244:247], v3 offset:1024
    v_cvt_pk_bf16_f32 v150, v108, v109
    v_mfma_f32_16x16x32_bf16 v[92:95], a[232:235], a[168:171], v[92:95]
    v_exp_f32 v71, v71
    v_mfma_f32_16x16x32_bf16 v[92:95], a[236:239], a[172:175], v[92:95]
    ds_read_b128 a[248:251], v3 offset:2048
    v_cvt_pk_bf16_f32 v151, v110, v111
    v_mfma_f32_16x16x32_bf16 v[108:111], a[224:227], a[176:179], v[244:247]
    v_exp_f32 v84, v84
    v_mfma_f32_16x16x32_bf16 v[108:111], a[228:231], a[180:183], v[108:111]
    ds_read_b128 a[252:255], v3 offset:3072
    v_cvt_pk_bf16_f32 v158, v124, v125
    v_mfma_f32_16x16x32_bf16 v[108:111], a[232:235], a[184:187], v[108:111]
    v_exp_f32 v85, v85
    v_mfma_f32_16x16x32_bf16 v[108:111], a[236:239], a[188:191], v[108:111]
    ds_read_b128 a[128:131], v3 offset:4096
    v_cvt_pk_bf16_f32 v159, v126, v127
    v_mfma_f32_16x16x32_bf16 v[124:127], a[224:227], a[192:195], v[244:247]
    v_exp_f32 v86, v86
    v_mfma_f32_16x16x32_bf16 v[124:127], a[228:231], a[196:199], v[124:127]
    ds_read_b128 a[132:135], v3 offset:5120
    ds_read_b128 v[56:59], v7 offset:0
    v_mfma_f32_16x16x32_bf16 v[124:127], a[232:235], a[200:203], v[124:127]
    v_exp_f32 v87, v87
    v_mfma_f32_16x16x32_bf16 v[124:127], a[236:239], a[204:207], v[124:127]
    s_waitcnt vmcnt(14) lgkmcnt(6)
    ds_write_b128 v4, v[224:227] offset:16512
    v_pk_fma_f32 v[160:161], v[160:161], v[248:249], v[252:253]
    v_pk_fma_f32 v[162:163], v[162:163], v[250:251], v[254:255]
    v_pk_fma_f32 v[164:165], v[164:165], v[248:249], v[252:253]
    v_pk_fma_f32 v[166:167], v[166:167], v[250:251], v[254:255]
    v_mfma_f32_16x16x32_bf16 a[0:3], v[128:131], a[240:243], a[0:3]
    s_waitcnt lgkmcnt(6)
    v_exp_f32 v100, v100
    v_mfma_f32_16x16x32_bf16 a[0:3], v[132:135], a[244:247], a[0:3]
    v_cvt_pk_bf16_f32 v160, v160, v161
    v_cvt_pk_bf16_f32 v162, v162, v163
    v_mfma_f32_16x16x32_bf16 a[4:7], v[136:139], a[240:243], a[4:7]
    v_exp_f32 v101, v101
    v_mfma_f32_16x16x32_bf16 a[4:7], v[140:143], a[244:247], a[4:7]
    ds_write_addtid_b32 v160 offset:0
    v_cvt_pk_bf16_f32 v164, v164, v165
    v_mfma_f32_16x16x32_bf16 a[8:11], v[144:147], a[240:243], a[8:11]
    v_exp_f32 v102, v102
    v_mfma_f32_16x16x32_bf16 a[8:11], v[148:151], a[244:247], a[8:11]
    ds_write_addtid_b32 v162 offset:1088
    v_cvt_pk_bf16_f32 v166, v166, v167
    v_mfma_f32_16x16x32_bf16 a[12:15], v[152:155], a[240:243], a[12:15]
    v_exp_f32 v103, v103
    v_mfma_f32_16x16x32_bf16 a[12:15], v[156:159], a[244:247], a[12:15]
    s_waitcnt lgkmcnt(3)
    ds_read_b128 a[240:243], v3 offset:6144
    ds_write_addtid_b32 v164 offset:272
    v_smfmac_f32_16x16x64_bf16 v[16:19], v[56:59], v[128:135], v60
    ds_read_b128 a[244:247], v3 offset:7168
    global_load_dwordx4 v[160:163], v1, s[6:7] offset:0 nt
    v_mfma_f32_16x16x32_bf16 a[16:19], v[128:131], a[248:251], a[16:19]
    v_exp_f32 v116, v116
    v_mfma_f32_16x16x32_bf16 a[16:19], v[132:135], a[252:255], a[16:19]
    ds_write_addtid_b32 v166 offset:1360
    global_load_dwordx4 v[164:167], v1, s[6:7] offset:512 nt
    v_mfma_f32_16x16x32_bf16 a[20:23], v[136:139], a[248:251], a[20:23]
    v_exp_f32 v117, v117
    v_mfma_f32_16x16x32_bf16 a[20:23], v[140:143], a[252:255], a[20:23]
    s_waitcnt vmcnt(14)
    ds_write_b128 v4, v[228:231] offset:18560
    v_pk_fma_f32 v[168:169], v[168:169], v[248:249], v[252:253]
    v_pk_fma_f32 v[170:171], v[170:171], v[250:251], v[254:255]
    v_pk_fma_f32 v[172:173], v[172:173], v[248:249], v[252:253]
    v_pk_fma_f32 v[174:175], v[174:175], v[250:251], v[254:255]
    v_mfma_f32_16x16x32_bf16 a[24:27], v[144:147], a[248:251], a[24:27]
    v_exp_f32 v118, v118
    v_mfma_f32_16x16x32_bf16 a[24:27], v[148:151], a[252:255], a[24:27]
    v_cvt_pk_bf16_f32 v168, v168, v169
    v_cvt_pk_bf16_f32 v170, v170, v171
    v_mfma_f32_16x16x32_bf16 a[28:31], v[152:155], a[248:251], a[28:31]
    v_exp_f32 v119, v119
    v_mfma_f32_16x16x32_bf16 a[28:31], v[156:159], a[252:255], a[28:31]
    ds_read_b128 a[248:251], v3 offset:8256
    v_cvt_pk_bf16_f32 v172, v172, v173
    v_mfma_f32_16x16x32_bf16 a[32:35], v[128:131], a[128:131], a[32:35]
    v_exp_f32 v72, v72
    v_mfma_f32_16x16x32_bf16 a[32:35], v[132:135], a[132:135], a[32:35]
    ds_read_b128 a[252:255], v3 offset:9280
    v_cvt_pk_bf16_f32 v174, v174, v175
    v_mfma_f32_16x16x32_bf16 a[36:39], v[136:139], a[128:131], a[36:39]
    v_exp_f32 v73, v73
    v_mfma_f32_16x16x32_bf16 a[36:39], v[140:143], a[132:135], a[36:39]
    ds_write_addtid_b32 v168 offset:544
    ds_write_addtid_b32 v170 offset:1632
    v_smfmac_f32_16x16x64_bf16 v[20:23], v[56:59], v[136:143], v60
    ds_write_addtid_b32 v172 offset:816
    global_load_dwordx4 v[168:171], v1, s[6:7] offset:1024 nt
    v_mfma_f32_16x16x32_bf16 a[40:43], v[144:147], a[128:131], a[40:43]
    v_exp_f32 v74, v74
    v_mfma_f32_16x16x32_bf16 a[40:43], v[148:151], a[132:135], a[40:43]
    ds_write_addtid_b32 v174 offset:1904
    global_load_dwordx4 v[172:175], v1, s[6:7] offset:1536 nt
    v_mfma_f32_16x16x32_bf16 a[44:47], v[152:155], a[128:131], a[44:47]
    v_exp_f32 v75, v75
    v_mfma_f32_16x16x32_bf16 a[44:47], v[156:159], a[132:135], a[44:47]
    s_waitcnt lgkmcnt(10)
    ds_read_b128 a[128:131], v3 offset:10304
    v_exp_f32 v88, v88
    v_mfma_f32_16x16x32_bf16 a[48:51], v[128:131], a[240:243], a[48:51]
    s_waitcnt lgkmcnt(9)
    v_exp_f32 v89, v89
    v_mfma_f32_16x16x32_bf16 a[48:51], v[132:135], a[244:247], a[48:51]
    ds_read_b128 a[132:135], v3 offset:11328
    v_exp_f32 v90, v90
    v_mfma_f32_16x16x32_bf16 a[52:55], v[136:139], a[240:243], a[52:55]
    v_exp_f32 v91, v91
    v_mfma_f32_16x16x32_bf16 a[52:55], v[140:143], a[244:247], a[52:55]
    s_waitcnt vmcnt(14)
    ds_write_b128 v4, v[232:235] offset:20608
    v_pk_fma_f32 v[176:177], v[176:177], v[248:249], v[252:253]
    v_pk_fma_f32 v[178:179], v[178:179], v[250:251], v[254:255]
    v_pk_fma_f32 v[180:181], v[180:181], v[248:249], v[252:253]
    v_pk_fma_f32 v[182:183], v[182:183], v[250:251], v[254:255]
    v_mfma_f32_16x16x32_bf16 a[56:59], v[144:147], a[240:243], a[56:59]
    v_exp_f32 v104, v104
    v_mfma_f32_16x16x32_bf16 a[56:59], v[148:151], a[244:247], a[56:59]
    v_cvt_pk_bf16_f32 v176, v176, v177
    v_cvt_pk_bf16_f32 v178, v178, v179
    v_mfma_f32_16x16x32_bf16 a[60:63], v[152:155], a[240:243], a[60:63]
    v_exp_f32 v105, v105
    v_mfma_f32_16x16x32_bf16 a[60:63], v[156:159], a[244:247], a[60:63]
    ds_read_b128 a[240:243], v3 offset:12352
    v_cvt_pk_bf16_f32 v180, v180, v181
    v_smfmac_f32_16x16x64_bf16 v[24:27], v[56:59], v[144:151], v60
    s_waitcnt lgkmcnt(9)
    ds_read_b128 a[244:247], v3 offset:13376
    v_cvt_pk_bf16_f32 v182, v182, v183
    v_mfma_f32_16x16x32_bf16 a[64:67], v[128:131], a[248:251], a[64:67]
    s_waitcnt lgkmcnt(9)
    v_exp_f32 v106, v106
    v_mfma_f32_16x16x32_bf16 a[64:67], v[132:135], a[252:255], a[64:67]
    ds_write_addtid_b32 v176 offset:2176
    ds_write_addtid_b32 v178 offset:3264
    v_mfma_f32_16x16x32_bf16 a[68:71], v[136:139], a[248:251], a[68:71]
    v_exp_f32 v107, v107
    v_mfma_f32_16x16x32_bf16 a[68:71], v[140:143], a[252:255], a[68:71]
    ds_write_addtid_b32 v180 offset:2448
    global_load_dwordx4 v[176:179], v1, s[6:7] offset:2048 nt
    v_mfma_f32_16x16x32_bf16 a[72:75], v[144:147], a[248:251], a[72:75]
    v_exp_f32 v120, v120
    v_mfma_f32_16x16x32_bf16 a[72:75], v[148:151], a[252:255], a[72:75]
    ds_write_addtid_b32 v182 offset:3536
    global_load_dwordx4 v[180:183], v1, s[6:7] offset:2560 nt
    v_mfma_f32_16x16x32_bf16 a[76:79], v[152:155], a[248:251], a[76:79]
    v_exp_f32 v121, v121
    v_mfma_f32_16x16x32_bf16 a[76:79], v[156:159], a[252:255], a[76:79]
    s_waitcnt lgkmcnt(8)
    ds_read_b128 a[248:251], v3 offset:14400
    v_exp_f32 v122, v122
    v_mfma_f32_16x16x32_bf16 a[80:83], v[128:131], a[128:131], a[80:83]
    s_waitcnt lgkmcnt(8)
    v_exp_f32 v123, v123
    v_mfma_f32_16x16x32_bf16 a[80:83], v[132:135], a[132:135], a[80:83]
    s_waitcnt vmcnt(14)
    ds_write_b128 v4, v[236:239] offset:22656
    v_pk_fma_f32 v[184:185], v[184:185], v[248:249], v[252:253]
    v_pk_fma_f32 v[186:187], v[186:187], v[250:251], v[254:255]
    v_pk_fma_f32 v[188:189], v[188:189], v[248:249], v[252:253]
    v_pk_fma_f32 v[190:191], v[190:191], v[250:251], v[254:255]
    v_mfma_f32_16x16x32_bf16 a[84:87], v[136:139], a[128:131], a[84:87]
    v_exp_f32 v76, v76
    v_mfma_f32_16x16x32_bf16 a[84:87], v[140:143], a[132:135], a[84:87]
    ds_read_b128 a[252:255], v3 offset:15424
    v_cvt_pk_bf16_f32 v184, v184, v185
    v_smfmac_f32_16x16x64_bf16 v[28:31], v[56:59], v[152:159], v60
    ds_write_addtid_b32 v184 offset:2720
    v_cvt_pk_bf16_f32 v186, v186, v187
    v_mfma_f32_16x16x32_bf16 a[88:91], v[144:147], a[128:131], a[88:91]
    v_exp_f32 v77, v77
    v_mfma_f32_16x16x32_bf16 a[88:91], v[148:151], a[132:135], a[88:91]
    ds_write_addtid_b32 v186 offset:3808
    v_cvt_pk_bf16_f32 v188, v188, v189
    v_mfma_f32_16x16x32_bf16 a[92:95], v[152:155], a[128:131], a[92:95]
    v_exp_f32 v78, v78
    v_mfma_f32_16x16x32_bf16 a[92:95], v[156:159], a[132:135], a[92:95]
    s_waitcnt lgkmcnt(10)
    ds_write_addtid_b32 v188 offset:2992
    v_cvt_pk_bf16_f32 v190, v190, v191
    v_mfma_f32_16x16x32_bf16 a[96:99], v[128:131], a[240:243], a[96:99]
    s_waitcnt lgkmcnt(10)
    v_exp_f32 v79, v79
    v_mfma_f32_16x16x32_bf16 a[96:99], v[132:135], a[244:247], a[96:99]
    ds_write_addtid_b32 v190 offset:4080
    v_exp_f32 v92, v92
    v_mfma_f32_16x16x32_bf16 a[100:103], v[136:139], a[240:243], a[100:103]
    v_exp_f32 v93, v93
    v_mfma_f32_16x16x32_bf16 a[100:103], v[140:143], a[244:247], a[100:103]
    ds_read_b128 v[240:243], v6 offset:3456
    v_exp_f32 v94, v94
    v_mfma_f32_16x16x32_bf16 a[104:107], v[144:147], a[240:243], a[104:107]
    v_exp_f32 v95, v95
    v_mfma_f32_16x16x32_bf16 a[104:107], v[148:151], a[244:247], a[104:107]
    s_waitcnt lgkmcnt(1)
    global_load_dwordx4 v[184:187], v1, s[6:7] offset:3072 nt
    v_exp_f32 v108, v108
    v_mfma_f32_16x16x32_bf16 a[108:111], v[152:155], a[240:243], a[108:111]
    s_barrier
    v_exp_f32 v109, v109
    v_mfma_f32_16x16x32_bf16 a[108:111], v[156:159], a[244:247], a[108:111]
    ds_read_b128 a[208:211], v2 offset:0
    global_load_dwordx4 v[188:191], v1, s[6:7] offset:3584 nt
    v_mfma_f32_16x16x32_bf16 a[112:115], v[128:131], a[248:251], a[112:115]
    v_exp_f32 v110, v110
    v_mfma_f32_16x16x32_bf16 a[112:115], v[132:135], a[252:255], a[112:115]
    ds_read_b128 a[212:215], v2 offset:16
    v_cvt_pk_bf16_f32 v128, v64, v65
    v_mfma_f32_16x16x32_bf16 a[116:119], v[136:139], a[248:251], a[116:119]
    v_exp_f32 v111, v111
    v_mfma_f32_16x16x32_bf16 a[116:119], v[140:143], a[252:255], a[116:119]
    ds_read_b128 a[216:219], v2 offset:32
    v_cvt_pk_bf16_f32 v129, v66, v67
    v_mfma_f32_16x16x32_bf16 a[120:123], v[144:147], a[248:251], a[120:123]
    v_exp_f32 v124, v124
    v_mfma_f32_16x16x32_bf16 a[120:123], v[148:151], a[252:255], a[120:123]
    ds_read_b128 a[220:223], v2 offset:48
    v_add_u32 v6, 3456, v6
    v_mfma_f32_16x16x32_bf16 a[124:127], v[152:155], a[248:251], a[124:127]
    v_exp_f32 v125, v125
    v_mfma_f32_16x16x32_bf16 a[124:127], v[156:159], a[252:255], a[124:127]
    s_waitcnt lgkmcnt(3)
    v_exp_f32 v126, v126
    v_exp_f32 v127, v127
    v_mfma_f32_16x16x32_bf16 v[64:67], a[208:211], a[144:147], v[240:243]
    s_waitcnt vmcnt(14) lgkmcnt(2)
    v_fma_f32 v224, v196, s24, v192
    v_fma_f32 v228, v197, s24, v193
    v_mfma_f32_16x16x32_bf16 v[64:67], a[212:215], a[148:151], v[64:67]
    s_waitcnt lgkmcnt(1)
    ds_read_b128 a[224:227], v2 offset:2176
    v_cvt_pk_bf16_f32 v136, v80, v81
    v_mfma_f32_16x16x32_bf16 v[64:67], a[216:219], a[152:155], v[64:67]
    s_waitcnt lgkmcnt(1)
    v_fma_f32 v232, v198, s24, v194
    v_fma_f32 v236, v199, s24, v195
    v_mfma_f32_16x16x32_bf16 v[64:67], a[220:223], a[156:159], v[64:67]
    s_cmp_eq_u32 s23, 1
    ds_read_b128 v[244:247], v6 offset:16
    v_cvt_pk_bf16_f32 v137, v82, v83
    v_mfma_f32_16x16x32_bf16 v[80:83], a[208:211], a[160:163], v[240:243]
    s_waitcnt vmcnt(12)
    v_fma_f32 v225, v204, s24, v200
    v_fma_f32 v229, v205, s24, v201
    v_mfma_f32_16x16x32_bf16 v[80:83], a[212:215], a[164:167], v[80:83]
    s_cselect_b32 s25, 0, 0x8000
    ds_read_b128 a[228:231], v2 offset:2192
    v_cvt_pk_bf16_f32 v144, v96, v97
    v_mfma_f32_16x16x32_bf16 v[80:83], a[216:219], a[168:171], v[80:83]
    s_add_u32 s6, s6, s25
    v_fma_f32 v233, v206, s24, v202
    v_fma_f32 v237, v207, s24, v203
    v_mfma_f32_16x16x32_bf16 v[80:83], a[220:223], a[172:175], v[80:83]
    s_addc_u32 s7, s7, 0
    ds_read_b128 a[232:235], v2 offset:2208
    v_cvt_pk_bf16_f32 v145, v98, v99
    v_mfma_f32_16x16x32_bf16 v[96:99], a[208:211], a[176:179], v[240:243]
    v_exp_f32 v64, v64
    v_mfma_f32_16x16x32_bf16 v[96:99], a[212:215], a[180:183], v[96:99]
    ds_read_b128 a[236:239], v2 offset:2224
    v_cvt_pk_bf16_f32 v152, v112, v113
    v_mfma_f32_16x16x32_bf16 v[96:99], a[216:219], a[184:187], v[96:99]
    v_exp_f32 v65, v65
    v_mfma_f32_16x16x32_bf16 v[96:99], a[220:223], a[188:191], v[96:99]
    global_load_dwordx4 v[192:195], v1, s[8:9] offset:0 nt
    v_cvt_pk_bf16_f32 v153, v114, v115
    v_mfma_f32_16x16x32_bf16 v[112:115], a[208:211], a[192:195], v[240:243]
    v_exp_f32 v66, v66
    v_mfma_f32_16x16x32_bf16 v[112:115], a[212:215], a[196:199], v[112:115]
    global_load_dwordx4 v[196:199], v1, s[8:9] offset:512 nt
    v_cvt_pk_bf16_f32 v130, v68, v69
    v_mfma_f32_16x16x32_bf16 v[112:115], a[216:219], a[200:203], v[112:115]
    v_exp_f32 v67, v67
    v_mfma_f32_16x16x32_bf16 v[112:115], a[220:223], a[204:207], v[112:115]
    s_waitcnt lgkmcnt(3)
    global_load_dwordx4 v[200:203], v1, s[8:9] offset:1024 nt
    v_cvt_pk_bf16_f32 v131, v70, v71
    v_mfma_f32_16x16x32_bf16 v[68:71], a[224:227], a[144:147], v[244:247]
    s_waitcnt lgkmcnt(2)
    v_exp_f32 v80, v80
    v_mfma_f32_16x16x32_bf16 v[68:71], a[228:231], a[148:151], v[68:71]
    s_waitcnt lgkmcnt(1)
    global_load_dwordx4 v[204:207], v1, s[8:9] offset:1536 nt
    v_cvt_pk_bf16_f32 v138, v84, v85
    v_mfma_f32_16x16x32_bf16 v[68:71], a[232:235], a[152:155], v[68:71]
    s_waitcnt lgkmcnt(0)
    v_exp_f32 v81, v81
    v_mfma_f32_16x16x32_bf16 v[68:71], a[236:239], a[156:159], v[68:71]
    ds_read_b128 a[208:211], v2 offset:8704
    v_cvt_pk_bf16_f32 v139, v86, v87
    v_mfma_f32_16x16x32_bf16 v[84:87], a[224:227], a[160:163], v[244:247]
    v_exp_f32 v82, v82
    v_mfma_f32_16x16x32_bf16 v[84:87], a[228:231], a[164:167], v[84:87]
    ds_read_b128 v[240:243], v6 offset:128
    v_cvt_pk_bf16_f32 v146, v100, v101
    v_mfma_f32_16x16x32_bf16 v[84:87], a[232:235], a[168:171], v[84:87]
    v_exp_f32 v83, v83
    v_mfma_f32_16x16x32_bf16 v[84:87], a[236:239], a[172:175], v[84:87]
    ds_read_b128 a[212:215], v2 offset:8720
    v_cvt_pk_bf16_f32 v147, v102, v103
    v_mfma_f32_16x16x32_bf16 v[100:103], a[224:227], a[176:179], v[244:247]
    s_waitcnt vmcnt(14)
    v_fma_f32 v226, v212, s24, v208
    v_fma_f32 v230, v213, s24, v209
    v_mfma_f32_16x16x32_bf16 v[100:103], a[228:231], a[180:183], v[100:103]
    ds_read_b128 a[216:219], v2 offset:8736
    v_cvt_pk_bf16_f32 v154, v116, v117
    v_mfma_f32_16x16x32_bf16 v[100:103], a[232:235], a[184:187], v[100:103]
    v_fma_f32 v234, v214, s24, v210
    v_fma_f32 v238, v215, s24, v211
    v_mfma_f32_16x16x32_bf16 v[100:103], a[236:239], a[188:191], v[100:103]
    ds_read_b128 a[220:223], v2 offset:8752
    v_cvt_pk_bf16_f32 v155, v118, v119
    v_mfma_f32_16x16x32_bf16 v[116:119], a[224:227], a[192:195], v[244:247]
    v_exp_f32 v96, v96
    v_mfma_f32_16x16x32_bf16 v[116:119], a[228:231], a[196:199], v[116:119]
    global_load_dwordx4 v[208:211], v1, s[8:9] offset:2048 nt
    v_cvt_pk_bf16_f32 v132, v72, v73
    v_mfma_f32_16x16x32_bf16 v[116:119], a[232:235], a[200:203], v[116:119]
    v_exp_f32 v97, v97
    v_mfma_f32_16x16x32_bf16 v[116:119], a[236:239], a[204:207], v[116:119]
    s_waitcnt lgkmcnt(3)
    global_load_dwordx4 v[212:215], v1, s[8:9] offset:2560 nt
    v_cvt_pk_bf16_f32 v133, v74, v75
    v_mfma_f32_16x16x32_bf16 v[72:75], a[208:211], a[144:147], v[240:243]
    s_waitcnt lgkmcnt(2)
    v_exp_f32 v98, v98
    v_mfma_f32_16x16x32_bf16 v[72:75], a[212:215], a[148:151], v[72:75]
    s_waitcnt lgkmcnt(1)
    ds_read_b128 a[224:227], v2 offset:10880
    v_cvt_pk_bf16_f32 v140, v88, v89
    v_mfma_f32_16x16x32_bf16 v[72:75], a[216:219], a[152:155], v[72:75]
    s_waitcnt lgkmcnt(1)
    v_exp_f32 v99, v99
    v_mfma_f32_16x16x32_bf16 v[72:75], a[220:223], a[156:159], v[72:75]
    ds_read_b128 v[244:247], v6 offset:144
    v_cvt_pk_bf16_f32 v141, v90, v91
    v_mfma_f32_16x16x32_bf16 v[88:91], a[208:211], a[160:163], v[240:243]
    v_exp_f32 v112, v112
    v_mfma_f32_16x16x32_bf16 v[88:91], a[212:215], a[164:167], v[88:91]
    ds_read_b128 a[228:231], v2 offset:10896
    v_cvt_pk_bf16_f32 v148, v104, v105
    v_mfma_f32_16x16x32_bf16 v[88:91], a[216:219], a[168:171], v[88:91]
    v_exp_f32 v113, v113
    v_mfma_f32_16x16x32_bf16 v[88:91], a[220:223], a[172:175], v[88:91]
    ds_read_b128 a[232:235], v2 offset:10912
    v_cvt_pk_bf16_f32 v149, v106, v107
    v_mfma_f32_16x16x32_bf16 v[104:107], a[208:211], a[176:179], v[240:243]
    s_waitcnt vmcnt(14)
    v_fma_f32 v227, v220, s24, v216
    v_fma_f32 v231, v221, s24, v217
    v_mfma_f32_16x16x32_bf16 v[104:107], a[212:215], a[180:183], v[104:107]
    ds_read_b128 a[236:239], v2 offset:10928
    v_cvt_pk_bf16_f32 v156, v120, v121
    v_mfma_f32_16x16x32_bf16 v[104:107], a[216:219], a[184:187], v[104:107]
    v_fma_f32 v235, v222, s24, v218
    v_fma_f32 v239, v223, s24, v219
    v_mfma_f32_16x16x32_bf16 v[104:107], a[220:223], a[188:191], v[104:107]
    global_load_dwordx4 v[216:219], v1, s[8:9] offset:3072 nt
    v_cvt_pk_bf16_f32 v157, v122, v123
    v_mfma_f32_16x16x32_bf16 v[120:123], a[208:211], a[192:195], v[240:243]
    v_exp_f32 v114, v114
    v_mfma_f32_16x16x32_bf16 v[120:123], a[212:215], a[196:199], v[120:123]
    global_load_dwordx4 v[220:223], v1, s[8:9] offset:3584 nt
    v_cvt_pk_bf16_f32 v134, v76, v77
    v_mfma_f32_16x16x32_bf16 v[120:123], a[216:219], a[200:203], v[120:123]
    v_exp_f32 v115, v115
    v_mfma_f32_16x16x32_bf16 v[120:123], a[220:223], a[204:207], v[120:123]
    s_waitcnt lgkmcnt(3)
    ds_read_b128 v[248:251], v5 offset:5184
    v_cvt_pk_bf16_f32 v135, v78, v79
    v_mfma_f32_16x16x32_bf16 v[76:79], a[224:227], a[144:147], v[244:247]
    s_waitcnt lgkmcnt(3)
    v_exp_f32 v68, v68
    v_mfma_f32_16x16x32_bf16 v[76:79], a[228:231], a[148:151], v[76:79]
    s_waitcnt lgkmcnt(2)
    ds_read_b128 v[252:255], v5 offset:5696
    v_cvt_pk_bf16_f32 v142, v92, v93
    v_mfma_f32_16x16x32_bf16 v[76:79], a[232:235], a[152:155], v[76:79]
    s_waitcnt lgkmcnt(2)
    v_exp_f32 v69, v69
    v_mfma_f32_16x16x32_bf16 v[76:79], a[236:239], a[156:159], v[76:79]
    s_add_u32 s8, s8, 0x8000
    ds_read_b128 a[240:243], v3 offset:16512
    v_cvt_pk_bf16_f32 v143, v94, v95
    v_mfma_f32_16x16x32_bf16 v[92:95], a[224:227], a[160:163], v[244:247]
    s_addc_u32 s9, s9, 0
    v_exp_f32 v70, v70
    v_mfma_f32_16x16x32_bf16 v[92:95], a[228:231], a[164:167], v[92:95]
    ds_read_b128 a[244:247], v3 offset:17536
    v_cvt_pk_bf16_f32 v150, v108, v109
    v_mfma_f32_16x16x32_bf16 v[92:95], a[232:235], a[168:171], v[92:95]
    v_exp_f32 v71, v71
    v_mfma_f32_16x16x32_bf16 v[92:95], a[236:239], a[172:175], v[92:95]
    ds_read_b128 a[248:251], v3 offset:18560
    v_cvt_pk_bf16_f32 v151, v110, v111
    v_add_u32 v5, 3456, v5
    v_mfma_f32_16x16x32_bf16 v[108:111], a[224:227], a[176:179], v[244:247]
    v_exp_f32 v84, v84
    v_mfma_f32_16x16x32_bf16 v[108:111], a[228:231], a[180:183], v[108:111]
    ds_read_b128 a[252:255], v3 offset:19584
    v_cvt_pk_bf16_f32 v158, v124, v125
    v_mfma_f32_16x16x32_bf16 v[108:111], a[232:235], a[184:187], v[108:111]
    v_exp_f32 v85, v85
    v_mfma_f32_16x16x32_bf16 v[108:111], a[236:239], a[188:191], v[108:111]
    ds_read_b128 a[128:131], v3 offset:20608
    v_cvt_pk_bf16_f32 v159, v126, v127
    v_mfma_f32_16x16x32_bf16 v[124:127], a[224:227], a[192:195], v[244:247]
    v_exp_f32 v86, v86
    v_mfma_f32_16x16x32_bf16 v[124:127], a[228:231], a[196:199], v[124:127]
    ds_read_b128 a[132:135], v3 offset:21632
    ds_read_b128 v[56:59], v7 offset:1728
    v_mfma_f32_16x16x32_bf16 v[124:127], a[232:235], a[200:203], v[124:127]
    v_exp_f32 v87, v87
    v_mfma_f32_16x16x32_bf16 v[124:127], a[236:239], a[204:207], v[124:127]
    s_waitcnt vmcnt(14) lgkmcnt(6)
    ds_write_b128 v4, v[224:227] offset:0
    v_pk_fma_f32 v[160:161], v[160:161], v[248:249], v[252:253]
    v_pk_fma_f32 v[162:163], v[162:163], v[250:251], v[254:255]
    v_pk_fma_f32 v[164:165], v[164:165], v[248:249], v[252:253]
    v_pk_fma_f32 v[166:167], v[166:167], v[250:251], v[254:255]
    v_mfma_f32_16x16x32_bf16 a[0:3], v[128:131], a[240:243], a[0:3]
    s_waitcnt lgkmcnt(6)
    v_exp_f32 v100, v100
    v_mfma_f32_16x16x32_bf16 a[0:3], v[132:135], a[244:247], a[0:3]
L_stub1:
    s_cbranch_vccnz L_back
    v_cvt_pk_bf16_f32 v160, v160, v161
    v_cvt_pk_bf16_f32 v162, v162, v163
    v_mfma_f32_16x16x32_bf16 a[4:7], v[136:139], a[240:243], a[4:7]
    v_exp_f32 v101, v101
    v_mfma_f32_16x16x32_bf16 a[4:7], v[140:143], a[244:247], a[4:7]
    ds_write_addtid_b32 v160 offset:17408
    v_cvt_pk_bf16_f32 v164, v164, v165
    v_mfma_f32_16x16x32_bf16 a[8:11], v[144:147], a[240:243], a[8:11]
    v_exp_f32 v102, v102
    v_mfma_f32_16x16x32_bf16 a[8:11], v[148:151], a[244:247], a[8:11]
    ds_write_addtid_b32 v162 offset:18496
    v_cvt_pk_bf16_f32 v166, v166, v167
    v_mfma_f32_16x16x32_bf16 a[12:15], v[152:155], a[240:243], a[12:15]
    v_exp_f32 v103, v103
    v_mfma_f32_16x16x32_bf16 a[12:15], v[156:159], a[244:247], a[12:15]
    s_waitcnt lgkmcnt(3)
    ds_read_b128 a[240:243], v3 offset:22656
    ds_write_addtid_b32 v164 offset:17680
    v_smfmac_f32_16x16x64_bf16 v[16:19], v[56:59], v[128:135], v60
    ds_read_b128 a[244:247], v3 offset:23680
    global_load_dwordx4 v[160:163], v1, s[6:7] offset:0 nt
    v_mfma_f32_16x16x32_bf16 a[16:19], v[128:131], a[248:251], a[16:19]
    v_exp_f32 v116, v116
    v_mfma_f32_16x16x32_bf16 a[16:19], v[132:135], a[252:255], a[16:19]
    ds_write_addtid_b32 v166 offset:18768
    global_load_dwordx4 v[164:167], v1, s[6:7] offset:512 nt
    v_mfma_f32_16x16x32_bf16 a[20:23], v[136:139], a[248:251], a[20:23]
    v_exp_f32 v117, v117
    v_mfma_f32_16x16x32_bf16 a[20:23], v[140:143], a[252:255], a[20:23]
    s_waitcnt vmcnt(14)
    ds_write_b128 v4, v[228:231] offset:2048
    v_pk_fma_f32 v[168:169], v[168:169], v[248:249], v[252:253]
    v_pk_fma_f32 v[170:171], v[170:171], v[250:251], v[254:255]
    v_pk_fma_f32 v[172:173], v[172:173], v[248:249], v[252:253]
    v_pk_fma_f32 v[174:175], v[174:175], v[250:251], v[254:255]
    v_mfma_f32_16x16x32_bf16 a[24:27], v[144:147], a[248:251], a[24:27]
    v_exp_f32 v118, v118
    v_mfma_f32_16x16x32_bf16 a[24:27], v[148:151], a[252:255], a[24:27]
    v_cvt_pk_bf16_f32 v168, v168, v169
    v_cvt_pk_bf16_f32 v170, v170, v171
    v_mfma_f32_16x16x32_bf16 a[28:31], v[152:155], a[248:251], a[28:31]
    v_exp_f32 v119, v119
    v_mfma_f32_16x16x32_bf16 a[28:31], v[156:159], a[252:255], a[28:31]
    ds_read_b128 a[248:251], v3 offset:24768
    v_cvt_pk_bf16_f32 v172, v172, v173
    v_mfma_f32_16x16x32_bf16 a[32:35], v[128:131], a[128:131], a[32:35]
    v_exp_f32 v72, v72
    v_mfma_f32_16x16x32_bf16 a[32:35], v[132:135], a[132:135], a[32:35]
    ds_read_b128 a[252:255], v3 offset:25792
    v_cvt_pk_bf16_f32 v174, v174, v175
    v_mfma_f32_16x16x32_bf16 a[36:39], v[136:139], a[128:131], a[36:39]
    v_exp_f32 v73, v73
    v_mfma_f32_16x16x32_bf16 a[36:39], v[140:143], a[132:135], a[36:39]
    ds_write_addtid_b32 v168 offset:17952
    ds_write_addtid_b32 v170 offset:19040
    v_smfmac_f32_16x16x64_bf16 v[20:23], v[56:59], v[136:143], v60
    ds_write_addtid_b32 v172 offset:18224
    global_load_dwordx4 v[168:171], v1, s[6:7] offset:1024 nt
    v_mfma_f32_16x16x32_bf16 a[40:43], v[144:147], a[128:131], a[40:43]
    v_exp_f32 v74, v74
    v_mfma_f32_16x16x32_bf16 a[40:43], v[148:151], a[132:135], a[40:43]
    ds_write_addtid_b32 v174 offset:19312
    global_load_dwordx4 v[172:175], v1, s[6:7] offset:1536 nt
    v_mfma_f32_16x16x32_bf16 a[44:47], v[152:155], a[128:131], a[44:47]
    v_exp_f32 v75, v75
    v_mfma_f32_16x16x32_bf16 a[44:47], v[156:159], a[132:135], a[44:47]
    s_waitcnt lgkmcnt(10)
    ds_read_b128 a[128:131], v3 offset:26816
    v_exp_f32 v88, v88
    v_mfma_f32_16x16x32_bf16 a[48:51], v[128:131], a[240:243], a[48:51]
    s_waitcnt lgkmcnt(9)
    v_exp_f32 v89, v89
    v_mfma_f32_16x16x32_bf16 a[48:51], v[132:135], a[244:247], a[48:51]
    ds_read_b128 a[132:135], v3 offset:27840
    v_exp_f32 v90, v90
    v_mfma_f32_16x16x32_bf16 a[52:55], v[136:139], a[240:243], a[52:55]
    v_exp_f32 v91, v91
    v_mfma_f32_16x16x32_bf16 a[52:55], v[140:143], a[244:247], a[52:55]
    s_waitcnt vmcnt(14)
    ds_write_b128 v4, v[232:235] offset:4096
    v_pk_fma_f32 v[176:177], v[176:177], v[248:249], v[252:253]
    v_pk_fma_f32 v[178:179], v[178:179], v[250:251], v[254:255]
    v_pk_fma_f32 v[180:181], v[180:181], v[248:249], v[252:253]
    v_pk_fma_f32 v[182:183], v[182:183], v[250:251], v[254:255]
    v_mfma_f32_16x16x32_bf16 a[56:59], v[144:147], a[240:243], a[56:59]
    v_exp_f32 v104, v104
    v_mfma_f32_16x16x32_bf16 a[56:59], v[148:151], a[244:247], a[56:59]
    v_cvt_pk_bf16_f32 v176, v176, v177
    v_cvt_pk_bf16_f32 v178, v178, v179
    v_mfma_f32_16x16x32_bf16 a[60:63], v[152:155], a[240:243], a[60:63]
    v_exp_f32 v105, v105
    v_mfma_f32_16x16x32_bf16 a[60:63], v[156:159], a[244:247], a[60:63]
    ds_read_b128 a[240:243], v3 offset:28864
    v_cvt_pk_bf16_f32 v180, v180, v181
    v_smfmac_f32_16x16x64_bf16 v[24:27], v[56:59], v[144:151], v60
    s_waitcnt lgkmcnt(9)
    ds_read_b128 a[244:247], v3 offset:29888
    v_cvt_pk_bf16_f32 v182, v182, v183
    v_mfma_f32_16x16x32_bf16 a[64:67], v[128:131], a[248:251], a[64:67]
    s_waitcnt lgkmcnt(9)
    v_exp_f32 v106, v106
    v_mfma_f32_16x16x32_bf16 a[64:67], v[132:135], a[252:255], a[64:67]
    ds_write_addtid_b32 v176 offset:19584
    ds_write_addtid_b32 v178 offset:20672
    v_mfma_f32_16x16x32_bf16 a[68:71], v[136:139], a[248:251], a[68:71]
    v_exp_f32 v107, v107
    v_mfma_f32_16x16x32_bf16 a[68:71], v[140:143], a[252:255], a[68:71]
    ds_write_addtid_b32 v180 offset:19856
    global_load_dwordx4 v[176:179], v1, s[6:7] offset:2048 nt
    v_mfma_f32_16x16x32_bf16 a[72:75], v[144:147], a[248:251], a[72:75]
    v_exp_f32 v120, v120
    v_mfma_f32_16x16x32_bf16 a[72:75], v[148:151], a[252:255], a[72:75]
    ds_write_addtid_b32 v182 offset:20944
    global_load_dwordx4 v[180:183], v1, s[6:7] offset:2560 nt
    v_mfma_f32_16x16x32_bf16 a[76:79], v[152:155], a[248:251], a[76:79]
    v_exp_f32 v121, v121
    v_mfma_f32_16x16x32_bf16 a[76:79], v[156:159], a[252:255], a[76:79]
    s_waitcnt lgkmcnt(8)
    ds_read_b128 a[248:251], v3 offset:30912
    v_exp_f32 v122, v122
    v_mfma_f32_16x16x32_bf16 a[80:83], v[128:131], a[128:131], a[80:83]
    s_waitcnt lgkmcnt(8)
    v_exp_f32 v123, v123
    v_mfma_f32_16x16x32_bf16 a[80:83], v[132:135], a[132:135], a[80:83]
    s_waitcnt vmcnt(14)
    ds_write_b128 v4, v[236:239] offset:6144
    v_pk_fma_f32 v[184:185], v[184:185], v[248:249], v[252:253]
    v_pk_fma_f32 v[186:187], v[186:187], v[250:251], v[254:255]
    v_pk_fma_f32 v[188:189], v[188:189], v[248:249], v[252:253]
    v_pk_fma_f32 v[190:191], v[190:191], v[250:251], v[254:255]
    v_mfma_f32_16x16x32_bf16 a[84:87], v[136:139], a[128:131], a[84:87]
    v_exp_f32 v76, v76
    v_mfma_f32_16x16x32_bf16 a[84:87], v[140:143], a[132:135], a[84:87]
    ds_read_b128 a[252:255], v3 offset:31936
    v_cvt_pk_bf16_f32 v184, v184, v185
    v_smfmac_f32_16x16x64_bf16 v[28:31], v[56:59], v[152:159], v60
    ds_write_addtid_b32 v184 offset:20128
    v_cvt_pk_bf16_f32 v186, v186, v187
    v_mfma_f32_16x16x32_bf16 a[88:91], v[144:147], a[128:131], a[88:91]
    s_sub_u32 s23, s23, 1
    v_exp_f32 v77, v77
    v_mfma_f32_16x16x32_bf16 a[88:91], v[148:151], a[132:135], a[88:91]
    s_cmp_lg_u32 s23, s45
    ds_write_addtid_b32 v186 offset:21216
    v_cvt_pk_bf16_f32 v188, v188, v189
    v_mfma_f32_16x16x32_bf16 a[92:95], v[152:155], a[128:131], a[92:95]
    v_exp_f32 v78, v78
    v_mfma_f32_16x16x32_bf16 a[92:95], v[156:159], a[132:135], a[92:95]
    s_waitcnt lgkmcnt(10)
    ds_write_addtid_b32 v188 offset:20400
    v_cvt_pk_bf16_f32 v190, v190, v191
    v_mfma_f32_16x16x32_bf16 a[96:99], v[128:131], a[240:243], a[96:99]
    s_waitcnt lgkmcnt(10)
    v_exp_f32 v79, v79
    v_mfma_f32_16x16x32_bf16 a[96:99], v[132:135], a[244:247], a[96:99]
    ds_write_addtid_b32 v190 offset:21488
    v_exp_f32 v92, v92
    v_mfma_f32_16x16x32_bf16 a[100:103], v[136:139], a[240:243], a[100:103]
    v_exp_f32 v93, v93
    v_mfma_f32_16x16x32_bf16 a[100:103], v[140:143], a[244:247], a[100:103]
    ds_read_b128 v[240:243], v6 offset:1728
    v_exp_f32 v94, v94
    v_mfma_f32_16x16x32_bf16 a[104:107], v[144:147], a[240:243], a[104:107]
    v_exp_f32 v95, v95
    v_mfma_f32_16x16x32_bf16 a[104:107], v[148:151], a[244:247], a[104:107]
    s_waitcnt lgkmcnt(1)
    global_load_dwordx4 v[184:187], v1, s[6:7] offset:3072 nt
    v_exp_f32 v108, v108
    v_mfma_f32_16x16x32_bf16 a[108:111], v[152:155], a[240:243], a[108:111]
    s_barrier
    v_exp_f32 v109, v109
    v_mfma_f32_16x16x32_bf16 a[108:111], v[156:159], a[244:247], a[108:111]
    ds_read_b128 a[208:211], v2 offset:17408
    global_load_dwordx4 v[188:191], v1, s[6:7] offset:3584 nt
    v_mfma_f32_16x16x32_bf16 a[112:115], v[128:131], a[248:251], a[112:115]
    v_exp_f32 v110, v110
    v_mfma_f32_16x16x32_bf16 a[112:115], v[132:135], a[252:255], a[112:115]
    ds_read_b128 a[212:215], v2 offset:17424
    v_cvt_pk_bf16_f32 v128, v64, v65
    v_mfma_f32_16x16x32_bf16 a[116:119], v[136:139], a[248:251], a[116:119]
    v_exp_f32 v111, v111
    v_mfma_f32_16x16x32_bf16 a[116:119], v[140:143], a[252:255], a[116:119]
    ds_read_b128 a[216:219], v2 offset:17440
    v_cvt_pk_bf16_f32 v129, v66, v67
    v_mfma_f32_16x16x32_bf16 a[120:123], v[144:147], a[248:251], a[120:123]
    v_exp_f32 v124, v124
    v_mfma_f32_16x16x32_bf16 a[120:123], v[148:151], a[252:255], a[120:123]
    ds_read_b128 a[220:223], v2 offset:17456
    v_add_u32 v7, 3456, v7
    v_mfma_f32_16x16x32_bf16 a[124:127], v[152:155], a[248:251], a[124:127]
    v_exp_f32 v125, v125
    v_mfma_f32_16x16x32_bf16 a[124:127], v[156:159], a[252:255], a[124:127]
    s_waitcnt lgkmcnt(3)
    v_exp_f32 v126, v126
    v_exp_f32 v127, v127
    s_cbranch_scc1 L_loop
    s_cmp_eq_u32 s45, 0
    s_cbranch_scc1 L_tail
    s_mov_b32 s45, 0
    s_add_u32 s46, s28, 0xf8000
    s_addc_u32 s47, s29, 0
    global_load_dword v53, v52, s[46:47]
    v_lshlrev_b32 v52, 1, v52
    s_add_u32 s46, s30, 0xf0000
    s_addc_u32 s47, s31, 0
    global_load_dword v53, v52, s[46:47]
    s_branch L_loop
L_tail:
    v_mfma_f32_16x16x32_bf16 v[64:67], a[208:211], a[144:147], v[240:243]
    s_waitcnt lgkmcnt(2)
    ds_read_b128 v[244:247], v6 offset:1744
    ds_read_b128 a[224:227], v2 offset:19584
    v_mfma_f32_16x16x32_bf16 v[64:67], a[212:215], a[148:151], v[64:67]
    s_waitcnt lgkmcnt(3)
    v_cvt_pk_bf16_f32 v136, v80, v81
    v_cvt_pk_bf16_f32 v137, v82, v83
    v_mfma_f32_16x16x32_bf16 v[64:67], a[216:219], a[152:155], v[64:67]
    s_waitcnt lgkmcnt(2)
    ds_read_b128 a[228:231], v2 offset:19600
    ds_read_b128 a[232:235], v2 offset:19616
    v_mfma_f32_16x16x32_bf16 v[64:67], a[220:223], a[156:159], v[64:67]
    ds_read_b128 a[236:239], v2 offset:19632
    v_cvt_pk_bf16_f32 v144, v96, v97
    v_mfma_f32_16x16x32_bf16 v[80:83], a[208:211], a[160:163], v[240:243]
    v_cvt_pk_bf16_f32 v145, v98, v99
    v_cvt_pk_bf16_f32 v152, v112, v113
    v_mfma_f32_16x16x32_bf16 v[80:83], a[212:215], a[164:167], v[80:83]
    v_cvt_pk_bf16_f32 v153, v114, v115
    v_cvt_pk_bf16_f32 v130, v68, v69
    v_mfma_f32_16x16x32_bf16 v[80:83], a[216:219], a[168:171], v[80:83]
    v_cvt_pk_bf16_f32 v131, v70, v71
    v_cvt_pk_bf16_f32 v138, v84, v85
    v_mfma_f32_16x16x32_bf16 v[80:83], a[220:223], a[172:175], v[80:83]
    v_cvt_pk_bf16_f32 v139, v86, v87
    v_cvt_pk_bf16_f32 v146, v100, v101
    v_mfma_f32_16x16x32_bf16 v[96:99], a[208:211], a[176:179], v[240:243]
    v_cvt_pk_bf16_f32 v147, v102, v103
    v_cvt_pk_bf16_f32 v154, v116, v117
    v_mfma_f32_16x16x32_bf16 v[96:99], a[212:215], a[180:183], v[96:99]
    v_cvt_pk_bf16_f32 v155, v118, v119
    v_cvt_pk_bf16_f32 v132, v72, v73
    v_mfma_f32_16x16x32_bf16 v[96:99], a[216:219], a[184:187], v[96:99]
    v_cvt_pk_bf16_f32 v133, v74, v75
    v_cvt_pk_bf16_f32 v140, v88, v89
    v_mfma_f32_16x16x32_bf16 v[96:99], a[220:223], a[188:191], v[96:99]
    v_cvt_pk_bf16_f32 v141, v90, v91
    v_cvt_pk_bf16_f32 v148, v104, v105
    v_mfma_f32_16x16x32_bf16 v[112:115], a[208:211], a[192:195], v[240:243]
    ds_read_b128 v[240:243], v6 offset:1856
    ds_read_b128 a[208:211], v2 offset:26112
    v_mfma_f32_16x16x32_bf16 v[112:115], a[212:215], a[196:199], v[112:115]
    ds_read_b128 a[212:215], v2 offset:26128
    v_cvt_pk_bf16_f32 v149, v106, v107
    v_mfma_f32_16x16x32_bf16 v[112:115], a[216:219], a[200:203], v[112:115]
    ds_read_b128 a[216:219], v2 offset:26144
    v_cvt_pk_bf16_f32 v156, v120, v121
    v_mfma_f32_16x16x32_bf16 v[112:115], a[220:223], a[204:207], v[112:115]
    s_waitcnt lgkmcnt(7)
    ds_read_b128 a[220:223], v2 offset:26160
    v_cvt_pk_bf16_f32 v157, v122, v123
    v_mfma_f32_16x16x32_bf16 v[68:71], a[224:227], a[144:147], v[244:247]
    s_waitcnt lgkmcnt(7)
    v_cvt_pk_bf16_f32 v134, v76, v77
    v_cvt_pk_bf16_f32 v135, v78, v79
    v_mfma_f32_16x16x32_bf16 v[68:71], a[228:231], a[148:151], v[68:71]
    s_waitcnt lgkmcnt(6)
    ds_read_b128 v[56:59], v7 offset:0
    ds_read_b128 a[240:243], v3 offset:0
    v_mfma_f32_16x16x32_bf16 v[68:71], a[232:235], a[152:155], v[68:71]
    s_waitcnt lgkmcnt(7)
    v_cvt_pk_bf16_f32 v142, v92, v93
    v_cvt_pk_bf16_f32 v143, v94, v95
    v_mfma_f32_16x16x32_bf16 v[68:71], a[236:239], a[156:159], v[68:71]
    s_waitcnt vmcnt(14)
    ds_read_b128 a[244:247], v3 offset:1024
    v_fma_f32 v224, v196, s24, v192
    v_mfma_f32_16x16x32_bf16 v[84:87], a[224:227], a[160:163], v[244:247]
    v_fma_f32 v228, v197, s24, v193
    v_fma_f32 v232, v198, s24, v194
    v_mfma_f32_16x16x32_bf16 v[84:87], a[228:231], a[164:167], v[84:87]
    s_waitcnt vmcnt(12)
    v_fma_f32 v236, v199, s24, v195
    v_fma_f32 v225, v204, s24, v200
    v_mfma_f32_16x16x32_bf16 v[84:87], a[232:235], a[168:171], v[84:87]
    v_fma_f32 v229, v205, s24, v201
    v_fma_f32 v233, v206, s24, v202
    v_mfma_f32_16x16x32_bf16 v[84:87], a[236:239], a[172:175], v[84:87]
    s_waitcnt vmcnt(10)
    v_fma_f32 v237, v207, s24, v203
    v_fma_f32 v226, v212, s24, v208
    v_mfma_f32_16x16x32_bf16 v[100:103], a[224:227], a[176:179], v[244:247]
    v_fma_f32 v230, v213, s24, v209
    v_fma_f32 v234, v214, s24, v210
    v_mfma_f32_16x16x32_bf16 v[100:103], a[228:231], a[180:183], v[100:103]
    s_waitcnt vmcnt(8)
    v_fma_f32 v238, v215, s24, v211
    v_fma_f32 v227, v220, s24, v216
    v_mfma_f32_16x16x32_bf16 v[100:103], a[232:235], a[184:187], v[100:103]
    ds_write_b128 v4, v[224:227] offset:16512
    v_mfma_f32_16x16x32_bf16 v[100:103], a[236:239], a[188:191], v[100:103]
    v_fma_f32 v231, v221, s24, v217
    v_fma_f32 v235, v222, s24, v218
    v_mfma_f32_16x16x32_bf16 v[116:119], a[224:227], a[192:195], v[244:247]
    ds_read_b128 v[244:247], v6 offset:1872
    ds_read_b128 a[224:227], v2 offset:28288
    v_mfma_f32_16x16x32_bf16 v[116:119], a[228:231], a[196:199], v[116:119]
    ds_read_b128 a[228:231], v2 offset:28304
    ds_write_b128 v4, v[228:231] offset:18560
    v_mfma_f32_16x16x32_bf16 v[116:119], a[232:235], a[200:203], v[116:119]
    ds_read_b128 a[232:235], v2 offset:28320
    ds_write_b128 v4, v[232:235] offset:20608
    v_mfma_f32_16x16x32_bf16 v[116:119], a[236:239], a[204:207], v[116:119]
    s_waitcnt lgkmcnt(13)
    ds_read_b128 a[236:239], v2 offset:28336
    v_fma_f32 v239, v223, s24, v219
    v_mfma_f32_16x16x32_bf16 v[72:75], a[208:211], a[144:147], v[240:243]
    s_waitcnt lgkmcnt(13)
    ds_write_b128 v4, v[236:239] offset:22656
    v_mfma_f32_16x16x32_bf16 v[72:75], a[212:215], a[148:151], v[72:75]
    s_waitcnt lgkmcnt(13)
    ds_read_b128 v[248:251], v7 offset:1728
    ds_read_b128 a[248:251], v3 offset:2048
    v_mfma_f32_16x16x32_bf16 v[72:75], a[216:219], a[152:155], v[72:75]
    s_waitcnt lgkmcnt(14)
    v_cvt_pk_bf16_f32 v150, v108, v109
    v_cvt_pk_bf16_f32 v151, v110, v111
    v_mfma_f32_16x16x32_bf16 v[72:75], a[220:223], a[156:159], v[72:75]
    ds_read_b128 a[252:255], v3 offset:3072
    s_waitcnt lgkmcnt(0)
    s_barrier
    v_mfma_f32_16x16x32_bf16 v[88:91], a[208:211], a[160:163], v[240:243]
    ds_read_b128 v[32:35], v3 offset:16512
    ds_read_b128 v[36:39], v3 offset:17536
    v_mfma_f32_16x16x32_bf16 v[88:91], a[212:215], a[164:167], v[88:91]
    ds_read_b128 v[40:43], v3 offset:18560
    ds_read_b128 v[44:47], v3 offset:19584
    v_mfma_f32_16x16x32_bf16 v[88:91], a[216:219], a[168:171], v[88:91]
    ds_read_b128 a[128:131], v3 offset:4096
    v_cvt_pk_bf16_f32 v158, v124, v125
    v_mfma_f32_16x16x32_bf16 v[88:91], a[220:223], a[172:175], v[88:91]
    v_cvt_pk_bf16_f32 v159, v126, v127
    v_exp_f32 v64, v64
    v_mfma_f32_16x16x32_bf16 v[104:107], a[208:211], a[176:179], v[240:243]
    ds_read_b128 a[132:135], v3 offset:5120
    ds_read_b128 v[192:195], v3 offset:20608
    v_mfma_f32_16x16x32_bf16 v[104:107], a[212:215], a[180:183], v[104:107]
    ds_read_b128 v[196:199], v3 offset:21632
    ds_read_b128 a[136:139], v3 offset:6144
    v_mfma_f32_16x16x32_bf16 v[104:107], a[216:219], a[184:187], v[104:107]
    ds_read_b128 a[140:143], v3 offset:7168
    v_exp_f32 v65, v65
    v_mfma_f32_16x16x32_bf16 v[104:107], a[220:223], a[188:191], v[104:107]
    v_exp_f32 v66, v66
    v_mfma_f32_16x16x32_bf16 v[120:123], a[208:211], a[192:195], v[240:243]
    v_exp_f32 v67, v67
    v_mfma_f32_16x16x32_bf16 v[120:123], a[212:215], a[196:199], v[120:123]
    v_cvt_pk_bf16_f32 v64, v64, v65
    v_cvt_pk_bf16_f32 v65, v66, v67
    v_mfma_f32_16x16x32_bf16 v[120:123], a[216:219], a[200:203], v[120:123]
    v_exp_f32 v68, v68
    v_mfma_f32_16x16x32_bf16 v[120:123], a[220:223], a[204:207], v[120:123]
    v_exp_f32 v69, v69
    v_mfma_f32_16x16x32_bf16 v[76:79], a[224:227], a[144:147], v[244:247]
    v_exp_f32 v70, v70
    v_mfma_f32_16x16x32_bf16 v[76:79], a[228:231], a[148:151], v[76:79]
    v_exp_f32 v71, v71
    v_mfma_f32_16x16x32_bf16 v[76:79], a[232:235], a[152:155], v[76:79]
    v_cvt_pk_bf16_f32 v66, v68, v69
    v_cvt_pk_bf16_f32 v67, v70, v71
    v_mfma_f32_16x16x32_bf16 v[76:79], a[236:239], a[156:159], v[76:79]
    ds_read_b128 v[200:203], v3 offset:22656
    v_exp_f32 v72, v72
    v_mfma_f32_16x16x32_bf16 v[92:95], a[224:227], a[160:163], v[244:247]
    v_exp_f32 v73, v73
    v_mfma_f32_16x16x32_bf16 v[92:95], a[228:231], a[164:167], v[92:95]
    v_exp_f32 v74, v74
    v_mfma_f32_16x16x32_bf16 v[92:95], a[232:235], a[168:171], v[92:95]
    v_exp_f32 v75, v75
    v_mfma_f32_16x16x32_bf16 v[92:95], a[236:239], a[172:175], v[92:95]
    v_exp_f32 v76, v76
    v_mfma_f32_16x16x32_bf16 v[108:111], a[224:227], a[176:179], v[244:247]
    v_exp_f32 v77, v77
    v_mfma_f32_16x16x32_bf16 v[108:111], a[228:231], a[180:183], v[108:111]
    v_exp_f32 v78, v78
    v_mfma_f32_16x16x32_bf16 v[108:111], a[232:235], a[184:187], v[108:111]
    v_exp_f32 v79, v79
    v_mfma_f32_16x16x32_bf16 v[108:111], a[236:239], a[188:191], v[108:111]
    v_cvt_pk_bf16_f32 v68, v72, v73
    v_cvt_pk_bf16_f32 v69, v74, v75
    v_mfma_f32_16x16x32_bf16 v[124:127], a[224:227], a[192:195], v[244:247]
    v_cvt_pk_bf16_f32 v70, v76, v77
    v_cvt_pk_bf16_f32 v71, v78, v79
    v_mfma_f32_16x16x32_bf16 v[124:127], a[228:231], a[196:199], v[124:127]
    s_waitcnt vmcnt(7)
    ds_read_b128 v[204:207], v3 offset:23680
    ds_read_b128 v[160:163], v3 offset:8256
    v_mfma_f32_16x16x32_bf16 v[124:127], a[232:235], a[200:203], v[124:127]
    s_waitcnt vmcnt(6)
    ds_read_b128 v[164:167], v3 offset:9280
    ds_read_b128 v[208:211], v3 offset:24768
    v_mfma_f32_16x16x32_bf16 v[124:127], a[236:239], a[204:207], v[124:127]
    s_waitcnt vmcnt(5)
    ds_read_b128 v[212:215], v3 offset:25792
    ds_read_b128 v[168:171], v3 offset:10304
    v_smfmac_f32_16x16x64_bf16 v[16:19], v[56:59], v[128:135], v60
    s_waitcnt vmcnt(4)
    ds_read_b128 v[172:175], v3 offset:11328
    ds_read_b128 v[216:219], v3 offset:26816
    v_mfma_f32_16x16x32_bf16 a[0:3], v[128:131], a[240:243], a[0:3]
    s_waitcnt vmcnt(3)
    ds_read_b128 v[220:223], v3 offset:27840
    ds_read_b128 v[176:179], v3 offset:12352
    v_mfma_f32_16x16x32_bf16 a[0:3], v[132:135], a[244:247], a[0:3]
    s_waitcnt vmcnt(2) lgkmcnt(15)
    ds_read_b128 v[180:183], v3 offset:13376
    ds_read_b128 v[224:227], v3 offset:28864
    v_mfma_f32_16x16x32_bf16 a[0:3], v[64:67], v[32:35], a[0:3]
    s_waitcnt vmcnt(1)
    ds_read_b128 v[228:231], v3 offset:29888
    ds_read_b128 v[184:187], v3 offset:14400
    v_mfma_f32_16x16x32_bf16 a[0:3], v[68:71], v[36:39], a[0:3]
    s_waitcnt vmcnt(0)
    ds_read_b128 v[188:191], v3 offset:15424
    ds_read_b128 v[232:235], v3 offset:30912
    v_smfmac_f32_16x16x64_bf16 v[16:19], v[248:251], v[64:71], v60
    ds_read_b128 v[236:239], v3 offset:31936
    s_mul_i32 s26, s22, 4352
    v_mfma_f32_16x16x32_bf16 a[16:19], v[128:131], a[248:251], a[16:19]
    v_and_b32 v15, 48, v0
    v_add_u32 v15, s26, v15
    v_mfma_f32_16x16x32_bf16 a[16:19], v[132:135], a[252:255], a[16:19]
    v_and_b32 v12, 63, v0
    s_movk_i32 s32, 133
    v_mfma_f32_16x16x32_bf16 a[16:19], v[64:67], v[40:43], a[16:19]
    v_lshlrev_b32 v12, 4, v12
    v_add_f32 v16, v16, v17
    v_mfma_f32_16x16x32_bf16 a[16:19], v[68:71], v[44:47], a[16:19]
    v_add_f32 v18, v18, v19
    v_add_f32 v16, v16, v18
    v_mfma_f32_16x16x32_bf16 a[32:35], v[128:131], a[128:131], a[32:35]
    ds_write_addtid_b32 v16 offset:0
    ds_read_b128 v[72:75], v15 offset:0
    v_mfma_f32_16x16x32_bf16 a[32:35], v[132:135], a[132:135], a[32:35]
    s_waitcnt lgkmcnt(15)
    ds_read_b128 v[76:79], v15 offset:64
    v_lshrrev_b32 v13, 6, v0
    v_mfma_f32_16x16x32_bf16 a[32:35], v[64:67], v[192:195], a[32:35]
    v_lshl_add_u32 v12, v13, 14, v12
    v_add_u32 v10, 0x1000, v12
    v_mfma_f32_16x16x32_bf16 a[32:35], v[68:71], v[196:199], a[32:35]
    v_mov_b32 v14, 0
    v_exp_f32 v80, v80
    v_mfma_f32_16x16x32_bf16 a[48:51], v[128:131], a[136:139], a[48:51]
    v_exp_f32 v81, v81
    v_mfma_f32_16x16x32_bf16 a[48:51], v[132:135], a[140:143], a[48:51]
    v_exp_f32 v82, v82
    v_mfma_f32_16x16x32_bf16 a[48:51], v[64:67], v[200:203], a[48:51]
    v_exp_f32 v83, v83
    v_mfma_f32_16x16x32_bf16 a[48:51], v[68:71], v[204:207], a[48:51]
    s_waitcnt lgkmcnt(1)
    v_rcp_f32 v16, v72
    v_mfma_f32_16x16x32_bf16 a[64:67], v[128:131], v[160:163], a[64:67]
    s_waitcnt lgkmcnt(0)
    v_mul_f32 v76, v76, v16
    v_ldexp_f32 v16, v16, s32
    v_mfma_f32_16x16x32_bf16 a[64:67], v[132:135], v[164:167], a[64:67]
    v_rcp_f32 v17, v73
    v_mfma_f32_16x16x32_bf16 a[64:67], v[64:67], v[208:211], a[64:67]
    v_rcp_f32 v18, v74
    v_mfma_f32_16x16x32_bf16 a[64:67], v[68:71], v[212:215], a[64:67]
    v_mul_f32 v77, v77, v17
    v_fma_f32 v14, v76, 0, v14
    v_mfma_f32_16x16x32_bf16 a[80:83], v[128:131], v[168:171], a[80:83]
    v_rcp_f32 v19, v75
    v_mfma_f32_16x16x32_bf16 a[80:83], v[132:135], v[172:175], a[80:83]
    v_mul_f32 v78, v78, v18
    v_fma_f32 v14, v77, 0, v14
    v_mfma_f32_16x16x32_bf16 a[80:83], v[64:67], v[216:219], a[80:83]
    v_mul_f32 v79, v79, v19
    v_fma_f32 v14, v78, 0, v14
    v_mfma_f32_16x16x32_bf16 a[80:83], v[68:71], v[220:223], a[80:83]
    v_fma_f32 v14, v79, 0, v14
    v_ldexp_f32 v17, v17, s32
    v_mfma_f32_16x16x32_bf16 a[96:99], v[128:131], v[176:179], a[96:99]
    v_ldexp_f32 v18, v18, s32
    v_cvt_pk_bf16_f32 v80, v80, v81
    v_mfma_f32_16x16x32_bf16 a[96:99], v[132:135], v[180:183], a[96:99]
    v_cvt_pk_bf16_f32 v81, v82, v83
    v_exp_f32 v84, v84
    v_mfma_f32_16x16x32_bf16 a[96:99], v[64:67], v[224:227], a[96:99]
    v_exp_f32 v85, v85
    v_mfma_f32_16x16x32_bf16 a[96:99], v[68:71], v[228:231], a[96:99]
    v_exp_f32 v86, v86
    v_mfma_f32_16x16x32_bf16 a[112:115], v[128:131], v[184:187], a[112:115]
    v_accvgpr_read_b32 v128, a0
    v_accvgpr_read_b32 v129, a16
    v_mfma_f32_16x16x32_bf16 a[112:115], v[132:135], v[188:191], a[112:115]
    v_accvgpr_read_b32 v130, a32
    v_accvgpr_read_b32 v131, a48
    v_mfma_f32_16x16x32_bf16 a[112:115], v[64:67], v[232:235], a[112:115]
    v_accvgpr_read_b32 v132, a64
    v_accvgpr_read_b32 v133, a80
    v_mfma_f32_16x16x32_bf16 a[112:115], v[68:71], v[236:239], a[112:115]
    v_accvgpr_read_b32 v134, a96
    v_fma_f32 v128, v128, v16, -v76
    v_smfmac_f32_16x16x64_bf16 v[20:23], v[56:59], v[136:143], v60
    v_fma_f32 v129, v129, v16, -v76
    v_mfma_f32_16x16x32_bf16 a[4:7], v[136:139], a[240:243], a[4:7]
    v_fma_f32 v130, v130, v16, -v76
    v_fma_f32 v131, v131, v16, -v76
    v_mfma_f32_16x16x32_bf16 a[4:7], v[140:143], a[244:247], a[4:7]
    v_fma_f32 v132, v132, v16, -v76
    v_accvgpr_read_b32 v135, a112
    v_fma_f32 v133, v133, v16, -v76
    v_fma_f32 v134, v134, v16, -v76
    v_fma_f32 v135, v135, v16, -v76
    v_cvt_pk_bf16_f32 v64, v128, v129
    v_cvt_pk_bf16_f32 v65, v130, v131
    v_cvt_pk_bf16_f32 v66, v132, v133
    v_cvt_pk_bf16_f32 v67, v134, v135
    global_store_dwordx4 v10, v[64:67], s[18:19] offset:-4096 sc1
    v_fma_f32 v14, v128, 0, v14
    v_fma_f32 v14, v129, 0, v14
    v_fma_f32 v14, v130, 0, v14
    v_fma_f32 v14, v131, 0, v14
    v_fma_f32 v14, v132, 0, v14
    v_fma_f32 v14, v133, 0, v14
    v_fma_f32 v14, v134, 0, v14
    v_fma_f32 v14, v135, 0, v14
    v_accvgpr_read_b32 v128, a1
    v_accvgpr_read_b32 v129, a17
    v_accvgpr_read_b32 v130, a33
    v_accvgpr_read_b32 v131, a49
    v_accvgpr_read_b32 v132, a65
    v_accvgpr_read_b32 v133, a81
    v_accvgpr_read_b32 v134, a97
    v_accvgpr_read_b32 v135, a113
    v_fma_f32 v128, v128, v17, -v77
    v_fma_f32 v129, v129, v17, -v77
    v_fma_f32 v130, v130, v17, -v77
    v_fma_f32 v131, v131, v17, -v77
    v_fma_f32 v132, v132, v17, -v77
    v_fma_f32 v133, v133, v17, -v77
    v_fma_f32 v134, v134, v17, -v77
    v_fma_f32 v135, v135, v17, -v77
    v_cvt_pk_bf16_f32 v68, v128, v129
    v_cvt_pk_bf16_f32 v69, v130, v131
    v_cvt_pk_bf16_f32 v70, v132, v133
    v_cvt_pk_bf16_f32 v71, v134, v135
    global_store_dwordx4 v10, v[68:71], s[18:19] offset:-3072 sc1
    v_accvgpr_read_b32 v128, a2
    v_accvgpr_read_b32 v129, a18
    v_accvgpr_read_b32 v130, a34
    v_accvgpr_read_b32 v131, a50
    v_accvgpr_read_b32 v132, a66
    v_accvgpr_read_b32 v133, a82
    v_accvgpr_read_b32 v134, a98
    v_accvgpr_read_b32 v135, a114
    v_fma_f32 v128, v128, v18, -v78
    v_fma_f32 v129, v129, v18, -v78
    v_fma_f32 v130, v130, v18, -v78
    v_fma_f32 v131, v131, v18, -v78
    v_fma_f32 v132, v132, v18, -v78
    v_fma_f32 v133, v133, v18, -v78
    v_fma_f32 v134, v134, v18, -v78
    v_fma_f32 v135, v135, v18, -v78
    v_cvt_pk_bf16_f32 v64, v128, v129
    v_cvt_pk_bf16_f32 v65, v130, v131
    v_cvt_pk_bf16_f32 v66, v132, v133
    v_cvt_pk_bf16_f32 v67, v134, v135
    global_store_dwordx4 v10, v[64:67], s[18:19] offset:-2048 sc1
    v_exp_f32 v87, v87
    v_cvt_pk_bf16_f32 v82, v84, v85
    v_cvt_pk_bf16_f32 v83, v86, v87
    v_exp_f32 v88, v88
    s_nop 0
    v_mfma_f32_16x16x32_bf16 a[4:7], v[80:83], v[32:35], a[4:7]
L_stub2:
    s_cbranch_vccnz L_back
    v_exp_f32 v89, v89
    v_exp_f32 v90, v90
    v_exp_f32 v91, v91
    v_exp_f32 v92, v92
    v_exp_f32 v93, v93
    v_exp_f32 v94, v94
    v_exp_f32 v95, v95
    v_cvt_pk_bf16_f32 v84, v88, v89
    v_cvt_pk_bf16_f32 v85, v90, v91
    v_cvt_pk_bf16_f32 v86, v92, v93
    v_cvt_pk_bf16_f32 v87, v94, v95
    v_ldexp_f32 v19, v19, s32
    v_accvgpr_read_b32 v128, a3
    v_mfma_f32_16x16x32_bf16 a[4:7], v[84:87], v[36:39], a[4:7]
    v_accvgpr_read_b32 v129, a19
    v_accvgpr_read_b32 v130, a35
    v_smfmac_f32_16x16x64_bf16 v[20:23], v[248:251], v[80:87], v60
    v_accvgpr_read_b32 v131, a51
    v_mfma_f32_16x16x32_bf16 a[20:23], v[136:139], a[248:251], a[20:23]
    v_accvgpr_read_b32 v132, a67
    v_accvgpr_read_b32 v133, a83
    v_mfma_f32_16x16x32_bf16 a[20:23], v[140:143], a[252:255], a[20:23]
    v_accvgpr_read_b32 v134, a99
    v_accvgpr_read_b32 v135, a115
    v_mfma_f32_16x16x32_bf16 a[20:23], v[80:83], v[40:43], a[20:23]
    v_fma_f32 v128, v128, v19, -v79
    v_fma_f32 v129, v129, v19, -v79
    v_mfma_f32_16x16x32_bf16 a[20:23], v[84:87], v[44:47], a[20:23]
    v_fma_f32 v130, v130, v19, -v79
    v_fma_f32 v131, v131, v19, -v79
    v_mfma_f32_16x16x32_bf16 a[36:39], v[136:139], a[128:131], a[36:39]
    v_fma_f32 v132, v132, v19, -v79
    v_fma_f32 v133, v133, v19, -v79
    v_mfma_f32_16x16x32_bf16 a[36:39], v[140:143], a[132:135], a[36:39]
    v_fma_f32 v134, v134, v19, -v79
    v_fma_f32 v135, v135, v19, -v79
    v_mfma_f32_16x16x32_bf16 a[36:39], v[80:83], v[192:195], a[36:39]
    v_cvt_pk_bf16_f32 v68, v128, v129
    v_cvt_pk_bf16_f32 v69, v130, v131
    v_mfma_f32_16x16x32_bf16 a[36:39], v[84:87], v[196:199], a[36:39]
    v_cvt_pk_bf16_f32 v70, v132, v133
    v_cvt_pk_bf16_f32 v71, v134, v135
    v_mfma_f32_16x16x32_bf16 a[52:55], v[136:139], a[136:139], a[52:55]
    global_store_dwordx4 v10, v[68:71], s[18:19] offset:-1024 sc1
    v_mfma_f32_16x16x32_bf16 a[52:55], v[140:143], a[140:143], a[52:55]
    v_add_f32 v20, v20, v21
    v_add_f32 v22, v22, v23
    v_mfma_f32_16x16x32_bf16 a[52:55], v[80:83], v[200:203], a[52:55]
    v_add_f32 v20, v20, v22
    ds_write_addtid_b32 v20 offset:256
    v_mfma_f32_16x16x32_bf16 a[52:55], v[84:87], v[204:207], a[52:55]
    ds_read_b128 v[88:91], v15 offset:256
    ds_read_b128 v[92:95], v15 offset:320
    v_mfma_f32_16x16x32_bf16 a[68:71], v[136:139], v[160:163], a[68:71]
    v_exp_f32 v96, v96
    v_mfma_f32_16x16x32_bf16 a[68:71], v[140:143], v[164:167], a[68:71]
    v_exp_f32 v97, v97
    v_mfma_f32_16x16x32_bf16 a[68:71], v[80:83], v[208:211], a[68:71]
    v_exp_f32 v98, v98
    v_mfma_f32_16x16x32_bf16 a[68:71], v[84:87], v[212:215], a[68:71]
    v_exp_f32 v99, v99
    v_mfma_f32_16x16x32_bf16 a[84:87], v[136:139], v[168:171], a[84:87]
    v_cvt_pk_bf16_f32 v96, v96, v97
    v_cvt_pk_bf16_f32 v97, v98, v99
    v_mfma_f32_16x16x32_bf16 a[84:87], v[140:143], v[172:175], a[84:87]
    v_exp_f32 v100, v100
    v_mfma_f32_16x16x32_bf16 a[84:87], v[80:83], v[216:219], a[84:87]
    s_waitcnt lgkmcnt(1)
    v_rcp_f32 v20, v88
    v_mfma_f32_16x16x32_bf16 a[84:87], v[84:87], v[220:223], a[84:87]
    s_waitcnt lgkmcnt(0)
    v_mul_f32 v92, v92, v20
    v_ldexp_f32 v20, v20, s32
    v_mfma_f32_16x16x32_bf16 a[100:103], v[136:139], v[176:179], a[100:103]
    v_rcp_f32 v21, v89
    v_mfma_f32_16x16x32_bf16 a[100:103], v[140:143], v[180:183], a[100:103]
    v_mul_f32 v93, v93, v21
    v_ldexp_f32 v21, v21, s32
    v_mfma_f32_16x16x32_bf16 a[100:103], v[80:83], v[224:227], a[100:103]
    v_rcp_f32 v22, v90
    v_mfma_f32_16x16x32_bf16 a[100:103], v[84:87], v[228:231], a[100:103]
    v_mul_f32 v94, v94, v22
    v_ldexp_f32 v22, v22, s32
    v_mfma_f32_16x16x32_bf16 a[116:119], v[136:139], v[184:187], a[116:119]
    v_accvgpr_read_b32 v136, a4
    v_accvgpr_read_b32 v137, a20
    v_mfma_f32_16x16x32_bf16 a[116:119], v[140:143], v[188:191], a[116:119]
    v_accvgpr_read_b32 v138, a36
    v_accvgpr_read_b32 v139, a52
    v_mfma_f32_16x16x32_bf16 a[116:119], v[80:83], v[232:235], a[116:119]
    v_accvgpr_read_b32 v140, a68
    v_accvgpr_read_b32 v141, a84
    v_mfma_f32_16x16x32_bf16 a[116:119], v[84:87], v[236:239], a[116:119]
    v_accvgpr_read_b32 v142, a100
    v_fma_f32 v136, v136, v20, -v92
    v_smfmac_f32_16x16x64_bf16 v[24:27], v[56:59], v[144:151], v60
    v_fma_f32 v137, v137, v20, -v92
    v_mfma_f32_16x16x32_bf16 a[8:11], v[144:147], a[240:243], a[8:11]
    v_fma_f32 v138, v138, v20, -v92
    v_fma_f32 v139, v139, v20, -v92
    v_mfma_f32_16x16x32_bf16 a[8:11], v[148:151], a[244:247], a[8:11]
    v_fma_f32 v140, v140, v20, -v92
    v_accvgpr_read_b32 v143, a116
    v_fma_f32 v141, v141, v20, -v92
    v_fma_f32 v142, v142, v20, -v92
    v_fma_f32 v143, v143, v20, -v92
    v_cvt_pk_bf16_f32 v80, v136, v137
    v_cvt_pk_bf16_f32 v81, v138, v139
    v_cvt_pk_bf16_f32 v82, v140, v141
    v_cvt_pk_bf16_f32 v83, v142, v143
    global_store_dwordx4 v10, v[80:83], s[18:19] offset:0 sc1
    v_accvgpr_read_b32 v136, a5
    v_accvgpr_read_b32 v137, a21
    v_accvgpr_read_b32 v138, a37
    v_accvgpr_read_b32 v139, a53
    v_accvgpr_read_b32 v140, a69
    v_accvgpr_read_b32 v141, a85
    v_accvgpr_read_b32 v142, a101
    v_accvgpr_read_b32 v143, a117
    v_fma_f32 v136, v136, v21, -v93
    v_fma_f32 v137, v137, v21, -v93
    v_fma_f32 v138, v138, v21, -v93
    v_fma_f32 v139, v139, v21, -v93
    v_fma_f32 v140, v140, v21, -v93
    v_fma_f32 v141, v141, v21, -v93
    v_fma_f32 v142, v142, v21, -v93
    v_fma_f32 v143, v143, v21, -v93
    v_cvt_pk_bf16_f32 v84, v136, v137
    v_cvt_pk_bf16_f32 v85, v138, v139
    v_cvt_pk_bf16_f32 v86, v140, v141
    v_cvt_pk_bf16_f32 v87, v142, v143
    global_store_dwordx4 v10, v[84:87], s[18:19] offset:1024 sc1
    v_accvgpr_read_b32 v136, a6
    v_accvgpr_read_b32 v137, a22
    v_accvgpr_read_b32 v138, a38
    v_accvgpr_read_b32 v139, a54
    v_accvgpr_read_b32 v140, a70
    v_accvgpr_read_b32 v141, a86
    v_accvgpr_read_b32 v142, a102
    v_accvgpr_read_b32 v143, a118
    v_fma_f32 v136, v136, v22, -v94
    v_fma_f32 v137, v137, v22, -v94
    v_fma_f32 v138, v138, v22, -v94
    v_fma_f32 v139, v139, v22, -v94
    v_fma_f32 v140, v140, v22, -v94
    v_fma_f32 v141, v141, v22, -v94
    v_fma_f32 v142, v142, v22, -v94
    v_fma_f32 v143, v143, v22, -v94
    v_cvt_pk_bf16_f32 v80, v136, v137
    v_cvt_pk_bf16_f32 v81, v138, v139
    v_cvt_pk_bf16_f32 v82, v140, v141
    v_cvt_pk_bf16_f32 v83, v142, v143
    global_store_dwordx4 v10, v[80:83], s[18:19] offset:2048 sc1
    v_exp_f32 v101, v101
    v_exp_f32 v102, v102
    v_exp_f32 v103, v103
    v_cvt_pk_bf16_f32 v98, v100, v101
    v_cvt_pk_bf16_f32 v99, v102, v103
    v_exp_f32 v104, v104
    s_nop 0
    v_mfma_f32_16x16x32_bf16 a[8:11], v[96:99], v[32:35], a[8:11]
    v_exp_f32 v105, v105
    v_exp_f32 v106, v106
    v_exp_f32 v107, v107
    v_exp_f32 v108, v108
    v_exp_f32 v109, v109
    v_exp_f32 v110, v110
    v_exp_f32 v111, v111
    v_cvt_pk_bf16_f32 v100, v104, v105
    v_cvt_pk_bf16_f32 v101, v106, v107
    v_cvt_pk_bf16_f32 v102, v108, v109
    v_cvt_pk_bf16_f32 v103, v110, v111
    v_rcp_f32 v23, v91
    s_nop 0
    v_mfma_f32_16x16x32_bf16 a[8:11], v[100:103], v[36:39], a[8:11]
    v_mul_f32 v95, v95, v23
    v_ldexp_f32 v23, v23, s32
    v_smfmac_f32_16x16x64_bf16 v[24:27], v[248:251], v[96:103], v60
    v_accvgpr_read_b32 v136, a7
    v_mfma_f32_16x16x32_bf16 a[24:27], v[144:147], a[248:251], a[24:27]
    v_accvgpr_read_b32 v137, a23
    v_accvgpr_read_b32 v138, a39
    v_mfma_f32_16x16x32_bf16 a[24:27], v[148:151], a[252:255], a[24:27]
    v_accvgpr_read_b32 v139, a55
    v_accvgpr_read_b32 v140, a71
    v_mfma_f32_16x16x32_bf16 a[24:27], v[96:99], v[40:43], a[24:27]
    v_accvgpr_read_b32 v141, a87
    v_accvgpr_read_b32 v142, a103
    v_mfma_f32_16x16x32_bf16 a[24:27], v[100:103], v[44:47], a[24:27]
    v_accvgpr_read_b32 v143, a119
    v_fma_f32 v136, v136, v23, -v95
    v_mfma_f32_16x16x32_bf16 a[40:43], v[144:147], a[128:131], a[40:43]
    v_fma_f32 v137, v137, v23, -v95
    v_fma_f32 v138, v138, v23, -v95
    v_mfma_f32_16x16x32_bf16 a[40:43], v[148:151], a[132:135], a[40:43]
    v_fma_f32 v139, v139, v23, -v95
    v_fma_f32 v140, v140, v23, -v95
    v_mfma_f32_16x16x32_bf16 a[40:43], v[96:99], v[192:195], a[40:43]
    v_fma_f32 v141, v141, v23, -v95
    v_fma_f32 v142, v142, v23, -v95
    v_mfma_f32_16x16x32_bf16 a[40:43], v[100:103], v[196:199], a[40:43]
    v_fma_f32 v143, v143, v23, -v95
    v_cvt_pk_bf16_f32 v84, v136, v137
    v_mfma_f32_16x16x32_bf16 a[56:59], v[144:147], a[136:139], a[56:59]
    v_cvt_pk_bf16_f32 v85, v138, v139
    v_cvt_pk_bf16_f32 v86, v140, v141
    v_mfma_f32_16x16x32_bf16 a[56:59], v[148:151], a[140:143], a[56:59]
    v_cvt_pk_bf16_f32 v87, v142, v143
    global_store_dwordx4 v10, v[84:87], s[18:19] offset:3072 sc1
    v_mfma_f32_16x16x32_bf16 a[56:59], v[96:99], v[200:203], a[56:59]
    v_add_f32 v24, v24, v25
    v_add_f32 v26, v26, v27
    v_mfma_f32_16x16x32_bf16 a[56:59], v[100:103], v[204:207], a[56:59]
    v_add_f32 v24, v24, v26
    ds_write_addtid_b32 v24 offset:512
    v_mfma_f32_16x16x32_bf16 a[72:75], v[144:147], v[160:163], a[72:75]
    ds_read_b128 v[104:107], v15 offset:512
    ds_read_b128 v[108:111], v15 offset:576
    v_mfma_f32_16x16x32_bf16 a[72:75], v[148:151], v[164:167], a[72:75]
    v_add_u32 v11, 0x3000, v12
    v_exp_f32 v112, v112
    v_mfma_f32_16x16x32_bf16 a[72:75], v[96:99], v[208:211], a[72:75]
    v_exp_f32 v113, v113
    v_mfma_f32_16x16x32_bf16 a[72:75], v[100:103], v[212:215], a[72:75]
    v_exp_f32 v114, v114
    v_mfma_f32_16x16x32_bf16 a[88:91], v[144:147], v[168:171], a[88:91]
    v_exp_f32 v115, v115
    v_mfma_f32_16x16x32_bf16 a[88:91], v[148:151], v[172:175], a[88:91]
    v_cvt_pk_bf16_f32 v112, v112, v113
    v_cvt_pk_bf16_f32 v113, v114, v115
    v_mfma_f32_16x16x32_bf16 a[88:91], v[96:99], v[216:219], a[88:91]
    v_exp_f32 v116, v116
    v_mfma_f32_16x16x32_bf16 a[88:91], v[100:103], v[220:223], a[88:91]
    s_waitcnt lgkmcnt(1)
    v_rcp_f32 v24, v104
    v_mfma_f32_16x16x32_bf16 a[104:107], v[144:147], v[176:179], a[104:107]
    s_waitcnt lgkmcnt(0)
    v_mul_f32 v108, v108, v24
    v_ldexp_f32 v24, v24, s32
    v_mfma_f32_16x16x32_bf16 a[104:107], v[148:151], v[180:183], a[104:107]
    v_rcp_f32 v25, v105
    v_mfma_f32_16x16x32_bf16 a[104:107], v[96:99], v[224:227], a[104:107]
    v_mul_f32 v109, v109, v25
    v_ldexp_f32 v25, v25, s32
    v_mfma_f32_16x16x32_bf16 a[104:107], v[100:103], v[228:231], a[104:107]
    v_rcp_f32 v26, v106
    v_mfma_f32_16x16x32_bf16 a[120:123], v[144:147], v[184:187], a[120:123]
    v_accvgpr_read_b32 v144, a8
    v_accvgpr_read_b32 v145, a24
    v_mfma_f32_16x16x32_bf16 a[120:123], v[148:151], v[188:191], a[120:123]
    v_accvgpr_read_b32 v146, a40
    v_accvgpr_read_b32 v147, a56
    v_mfma_f32_16x16x32_bf16 a[120:123], v[96:99], v[232:235], a[120:123]
    v_accvgpr_read_b32 v148, a72
    v_accvgpr_read_b32 v149, a88
    v_mfma_f32_16x16x32_bf16 a[120:123], v[100:103], v[236:239], a[120:123]
    v_accvgpr_read_b32 v150, a104
    v_fma_f32 v144, v144, v24, -v108
    v_smfmac_f32_16x16x64_bf16 v[28:31], v[56:59], v[152:159], v60
    v_fma_f32 v145, v145, v24, -v108
    v_mfma_f32_16x16x32_bf16 a[12:15], v[152:155], a[240:243], a[12:15]
    v_fma_f32 v146, v146, v24, -v108
    v_fma_f32 v147, v147, v24, -v108
    v_mfma_f32_16x16x32_bf16 a[12:15], v[156:159], a[244:247], a[12:15]
    v_fma_f32 v148, v148, v24, -v108
    v_accvgpr_read_b32 v151, a120
    v_fma_f32 v149, v149, v24, -v108
    v_fma_f32 v150, v150, v24, -v108
    v_fma_f32 v151, v151, v24, -v108
    v_cvt_pk_bf16_f32 v96, v144, v145
    v_cvt_pk_bf16_f32 v97, v146, v147
    v_cvt_pk_bf16_f32 v98, v148, v149
    v_cvt_pk_bf16_f32 v99, v150, v151
    global_store_dwordx4 v11, v[96:99], s[18:19] offset:-4096 sc1
    v_accvgpr_read_b32 v144, a9
    v_accvgpr_read_b32 v145, a25
    v_accvgpr_read_b32 v146, a41
    v_accvgpr_read_b32 v147, a57
    v_accvgpr_read_b32 v148, a73
    v_accvgpr_read_b32 v149, a89
    v_accvgpr_read_b32 v150, a105
    v_accvgpr_read_b32 v151, a121
    v_fma_f32 v144, v144, v25, -v109
    v_fma_f32 v145, v145, v25, -v109
    v_fma_f32 v146, v146, v25, -v109
    v_fma_f32 v147, v147, v25, -v109
    v_fma_f32 v148, v148, v25, -v109
    v_fma_f32 v149, v149, v25, -v109
    v_fma_f32 v150, v150, v25, -v109
    v_fma_f32 v151, v151, v25, -v109
    v_cvt_pk_bf16_f32 v100, v144, v145
    v_cvt_pk_bf16_f32 v101, v146, v147
    v_cvt_pk_bf16_f32 v102, v148, v149
    v_cvt_pk_bf16_f32 v103, v150, v151
    global_store_dwordx4 v11, v[100:103], s[18:19] offset:-3072 sc1
    v_mul_f32 v110, v110, v26
    v_ldexp_f32 v26, v26, s32
    v_accvgpr_read_b32 v144, a10
    v_accvgpr_read_b32 v145, a26
    v_accvgpr_read_b32 v146, a42
    v_accvgpr_read_b32 v147, a58
    v_accvgpr_read_b32 v148, a74
    v_accvgpr_read_b32 v149, a90
    v_accvgpr_read_b32 v150, a106
    v_accvgpr_read_b32 v151, a122
    v_fma_f32 v144, v144, v26, -v110
    v_fma_f32 v145, v145, v26, -v110
    v_fma_f32 v146, v146, v26, -v110
    v_fma_f32 v147, v147, v26, -v110
    v_fma_f32 v148, v148, v26, -v110
    v_fma_f32 v149, v149, v26, -v110
    v_fma_f32 v150, v150, v26, -v110
    v_fma_f32 v151, v151, v26, -v110
    v_cvt_pk_bf16_f32 v96, v144, v145
    v_cvt_pk_bf16_f32 v97, v146, v147
    v_cvt_pk_bf16_f32 v98, v148, v149
    v_cvt_pk_bf16_f32 v99, v150, v151
    global_store_dwordx4 v11, v[96:99], s[18:19] offset:-2048 sc1
    v_exp_f32 v117, v117
    v_exp_f32 v118, v118
    v_exp_f32 v119, v119
    v_cvt_pk_bf16_f32 v114, v116, v117
    v_cvt_pk_bf16_f32 v115, v118, v119
    v_exp_f32 v120, v120
    s_nop 0
    v_mfma_f32_16x16x32_bf16 a[12:15], v[112:115], v[32:35], a[12:15]
    v_exp_f32 v121, v121
    v_exp_f32 v122, v122
    v_exp_f32 v123, v123
    v_exp_f32 v124, v124
    v_exp_f32 v125, v125
    v_exp_f32 v126, v126
    v_exp_f32 v127, v127
    v_cvt_pk_bf16_f32 v116, v120, v121
    v_cvt_pk_bf16_f32 v117, v122, v123
    v_cvt_pk_bf16_f32 v118, v124, v125
    v_cvt_pk_bf16_f32 v119, v126, v127
    v_rcp_f32 v27, v107
    s_nop 0
    v_mfma_f32_16x16x32_bf16 a[12:15], v[116:119], v[36:39], a[12:15]
    v_mul_f32 v111, v111, v27
    v_ldexp_f32 v27, v27, s32
    v_smfmac_f32_16x16x64_bf16 v[28:31], v[248:251], v[112:119], v60
    v_accvgpr_read_b32 v144, a11
    v_mfma_f32_16x16x32_bf16 a[28:31], v[152:155], a[248:251], a[28:31]
    v_accvgpr_read_b32 v145, a27
    v_accvgpr_read_b32 v146, a43
    v_mfma_f32_16x16x32_bf16 a[28:31], v[156:159], a[252:255], a[28:31]
    v_accvgpr_read_b32 v147, a59
    v_accvgpr_read_b32 v148, a75
    v_mfma_f32_16x16x32_bf16 a[28:31], v[112:115], v[40:43], a[28:31]
    v_accvgpr_read_b32 v149, a91
    v_accvgpr_read_b32 v150, a107
    v_mfma_f32_16x16x32_bf16 a[28:31], v[116:119], v[44:47], a[28:31]
    v_accvgpr_read_b32 v151, a123
    v_fma_f32 v144, v144, v27, -v111
    v_mfma_f32_16x16x32_bf16 a[44:47], v[152:155], a[128:131], a[44:47]
    v_fma_f32 v145, v145, v27, -v111
    v_fma_f32 v146, v146, v27, -v111
    v_mfma_f32_16x16x32_bf16 a[44:47], v[156:159], a[132:135], a[44:47]
    v_fma_f32 v147, v147, v27, -v111
    v_fma_f32 v148, v148, v27, -v111
    v_mfma_f32_16x16x32_bf16 a[44:47], v[112:115], v[192:195], a[44:47]
    v_fma_f32 v149, v149, v27, -v111
    v_fma_f32 v150, v150, v27, -v111
    v_mfma_f32_16x16x32_bf16 a[44:47], v[116:119], v[196:199], a[44:47]
    v_fma_f32 v151, v151, v27, -v111
    v_cvt_pk_bf16_f32 v100, v144, v145
    v_mfma_f32_16x16x32_bf16 a[60:63], v[152:155], a[136:139], a[60:63]
    v_cvt_pk_bf16_f32 v101, v146, v147
    v_cvt_pk_bf16_f32 v102, v148, v149
    v_mfma_f32_16x16x32_bf16 a[60:63], v[156:159], a[140:143], a[60:63]
    v_cvt_pk_bf16_f32 v103, v150, v151
    global_store_dwordx4 v11, v[100:103], s[18:19] offset:-1024 sc1
    v_mfma_f32_16x16x32_bf16 a[60:63], v[112:115], v[200:203], a[60:63]
    v_add_f32 v28, v28, v29
    v_add_f32 v30, v30, v31
    v_mfma_f32_16x16x32_bf16 a[60:63], v[116:119], v[204:207], a[60:63]
    v_add_f32 v28, v28, v30
    ds_write_addtid_b32 v28 offset:768
    v_mfma_f32_16x16x32_bf16 a[76:79], v[152:155], v[160:163], a[76:79]
    ds_read_b128 v[120:123], v15 offset:768
    ds_read_b128 v[124:127], v15 offset:832
    v_mfma_f32_16x16x32_bf16 a[76:79], v[156:159], v[164:167], a[76:79]
    v_fma_f32 v14, v92, 0, v14
    v_fma_f32 v14, v93, 0, v14
    v_mfma_f32_16x16x32_bf16 a[76:79], v[112:115], v[208:211], a[76:79]
    v_fma_f32 v14, v94, 0, v14
    v_mov_b32 v12, -1
    v_mfma_f32_16x16x32_bf16 a[76:79], v[116:119], v[212:215], a[76:79]
    v_mov_b32 v13, 0
    v_fma_f32 v14, v95, 0, v14
    v_mfma_f32_16x16x32_bf16 a[92:95], v[152:155], v[168:171], a[92:95]
    v_min3_u32 v12, v72, v73, v12
    v_max3_u32 v13, v72, v73, v13
    v_mfma_f32_16x16x32_bf16 a[92:95], v[156:159], v[172:175], a[92:95]
    v_fma_f32 v14, v108, 0, v14
    v_min3_u32 v12, v74, v75, v12
    v_mfma_f32_16x16x32_bf16 a[92:95], v[112:115], v[216:219], a[92:95]
    v_max3_u32 v13, v74, v75, v13
    v_fma_f32 v14, v109, 0, v14
    v_mfma_f32_16x16x32_bf16 a[92:95], v[116:119], v[220:223], a[92:95]
    s_waitcnt lgkmcnt(1)
    v_rcp_f32 v28, v120
    v_mfma_f32_16x16x32_bf16 a[108:111], v[152:155], v[176:179], a[108:111]
    v_rcp_f32 v29, v121
    v_mfma_f32_16x16x32_bf16 a[108:111], v[156:159], v[180:183], a[108:111]
    s_waitcnt lgkmcnt(0)
    v_mul_f32 v124, v124, v28
    v_mul_f32 v125, v125, v29
    v_mfma_f32_16x16x32_bf16 a[108:111], v[112:115], v[224:227], a[108:111]
    v_ldexp_f32 v28, v28, s32
    v_ldexp_f32 v29, v29, s32
    v_mfma_f32_16x16x32_bf16 a[108:111], v[116:119], v[228:231], a[108:111]
    v_rcp_f32 v30, v122
    v_mfma_f32_16x16x32_bf16 a[124:127], v[152:155], v[184:187], a[124:127]
    v_accvgpr_read_b32 v152, a12
    v_accvgpr_read_b32 v153, a28
    v_mfma_f32_16x16x32_bf16 a[124:127], v[156:159], v[188:191], a[124:127]
    v_accvgpr_read_b32 v154, a44
    v_accvgpr_read_b32 v155, a60
    v_mfma_f32_16x16x32_bf16 a[124:127], v[112:115], v[232:235], a[124:127]
    v_accvgpr_read_b32 v156, a76
    v_accvgpr_read_b32 v157, a92
    v_mfma_f32_16x16x32_bf16 a[124:127], v[116:119], v[236:239], a[124:127]
    v_accvgpr_read_b32 v158, a108
    v_rcp_f32 v31, v123
    v_mul_f32 v126, v126, v30
    v_mul_f32 v127, v127, v31
    v_pk_fma_f32 v[152:153], v[152:153], v[28:29], v[124:125] op_sel:[0,0,0] op_sel_hi:[1,0,0] neg_lo:[0,0,1] neg_hi:[0,0,1]
    v_pk_fma_f32 v[154:155], v[154:155], v[28:29], v[124:125] op_sel:[0,0,0] op_sel_hi:[1,0,0] neg_lo:[0,0,1] neg_hi:[0,0,1]
    v_pk_fma_f32 v[156:157], v[156:157], v[28:29], v[124:125] op_sel:[0,0,0] op_sel_hi:[1,0,0] neg_lo:[0,0,1] neg_hi:[0,0,1]
    v_cvt_pk_bf16_f32 v112, v152, v153
    v_cvt_pk_bf16_f32 v113, v154, v155
    v_cvt_pk_bf16_f32 v114, v156, v157
    v_accvgpr_read_b32 v152, a13
    v_accvgpr_read_b32 v153, a29
    v_accvgpr_read_b32 v159, a124
    v_pk_fma_f32 v[158:159], v[158:159], v[28:29], v[124:125] op_sel:[0,0,0] op_sel_hi:[1,0,0] neg_lo:[0,0,1] neg_hi:[0,0,1]
    v_cvt_pk_bf16_f32 v115, v158, v159
    global_store_dwordx4 v11, v[112:115], s[18:19] offset:0 sc1
    v_accvgpr_read_b32 v154, a45
    v_accvgpr_read_b32 v155, a61
    v_accvgpr_read_b32 v156, a77
    v_accvgpr_read_b32 v157, a93
    v_accvgpr_read_b32 v158, a109
    v_accvgpr_read_b32 v159, a125
    v_pk_fma_f32 v[152:153], v[152:153], v[28:29], v[124:125] op_sel:[0,1,1] op_sel_hi:[1,1,1] neg_lo:[0,0,1] neg_hi:[0,0,1]
    v_pk_fma_f32 v[154:155], v[154:155], v[28:29], v[124:125] op_sel:[0,1,1] op_sel_hi:[1,1,1] neg_lo:[0,0,1] neg_hi:[0,0,1]
    v_pk_fma_f32 v[156:157], v[156:157], v[28:29], v[124:125] op_sel:[0,1,1] op_sel_hi:[1,1,1] neg_lo:[0,0,1] neg_hi:[0,0,1]
    v_pk_fma_f32 v[158:159], v[158:159], v[28:29], v[124:125] op_sel:[0,1,1] op_sel_hi:[1,1,1] neg_lo:[0,0,1] neg_hi:[0,0,1]
    v_cvt_pk_bf16_f32 v116, v152, v153
    v_cvt_pk_bf16_f32 v117, v154, v155
    v_cvt_pk_bf16_f32 v118, v156, v157
    v_cvt_pk_bf16_f32 v119, v158, v159
    global_store_dwordx4 v11, v[116:119], s[18:19] offset:1024 sc1
    v_ldexp_f32 v30, v30, s32
    v_ldexp_f32 v31, v31, s32
    v_accvgpr_read_b32 v152, a14
    v_accvgpr_read_b32 v153, a30
    v_accvgpr_read_b32 v154, a46
    v_accvgpr_read_b32 v155, a62
    v_accvgpr_read_b32 v156, a78
    v_accvgpr_read_b32 v157, a94
    v_accvgpr_read_b32 v158, a110
    v_accvgpr_read_b32 v159, a126
    v_pk_fma_f32 v[152:153], v[152:153], v[30:31], v[126:127] op_sel:[0,0,0] op_sel_hi:[1,0,0] neg_lo:[0,0,1] neg_hi:[0,0,1]
    v_pk_fma_f32 v[154:155], v[154:155], v[30:31], v[126:127] op_sel:[0,0,0] op_sel_hi:[1,0,0] neg_lo:[0,0,1] neg_hi:[0,0,1]
    v_pk_fma_f32 v[156:157], v[156:157], v[30:31], v[126:127] op_sel:[0,0,0] op_sel_hi:[1,0,0] neg_lo:[0,0,1] neg_hi:[0,0,1]
    v_pk_fma_f32 v[158:159], v[158:159], v[30:31], v[126:127] op_sel:[0,0,0] op_sel_hi:[1,0,0] neg_lo:[0,0,1] neg_hi:[0,0,1]
    v_cvt_pk_bf16_f32 v112, v152, v153
    v_cvt_pk_bf16_f32 v113, v154, v155
    v_cvt_pk_bf16_f32 v114, v156, v157
    v_cvt_pk_bf16_f32 v115, v158, v159
    global_store_dwordx4 v11, v[112:115], s[18:19] offset:2048 sc1
    v_min3_u32 v12, v88, v89, v12
    v_max3_u32 v13, v88, v89, v13
    v_fma_f32 v14, v110, 0, v14
    v_min3_u32 v12, v90, v91, v12
    v_max3_u32 v13, v90, v91, v13
    v_fma_f32 v14, v111, 0, v14
    v_min3_u32 v12, v104, v105, v12
    v_max3_u32 v13, v104, v105, v13
    v_fma_f32 v14, v124, 0, v14
    v_accvgpr_read_b32 v152, a15
    v_accvgpr_read_b32 v153, a31
    v_accvgpr_read_b32 v154, a47
    v_accvgpr_read_b32 v155, a63
    v_accvgpr_read_b32 v156, a79
    v_accvgpr_read_b32 v157, a95
    v_accvgpr_read_b32 v158, a111
    v_accvgpr_read_b32 v159, a127
    v_min3_u32 v12, v106, v107, v12
    v_max3_u32 v13, v106, v107, v13
    v_fma_f32 v14, v125, 0, v14
    v_pk_fma_f32 v[152:153], v[152:153], v[30:31], v[126:127] op_sel:[0,1,1] op_sel_hi:[1,1,1] neg_lo:[0,0,1] neg_hi:[0,0,1]
    v_pk_fma_f32 v[154:155], v[154:155], v[30:31], v[126:127] op_sel:[0,1,1] op_sel_hi:[1,1,1] neg_lo:[0,0,1] neg_hi:[0,0,1]
    v_pk_fma_f32 v[156:157], v[156:157], v[30:31], v[126:127] op_sel:[0,1,1] op_sel_hi:[1,1,1] neg_lo:[0,0,1] neg_hi:[0,0,1]
    v_pk_fma_f32 v[158:159], v[158:159], v[30:31], v[126:127] op_sel:[0,1,1] op_sel_hi:[1,1,1] neg_lo:[0,0,1] neg_hi:[0,0,1]
    v_min3_u32 v12, v120, v121, v12
    v_max3_u32 v13, v120, v121, v13
    v_fma_f32 v14, v126, 0, v14
    v_cvt_pk_bf16_f32 v116, v152, v153
    v_cvt_pk_bf16_f32 v117, v154, v155
    v_cvt_pk_bf16_f32 v118, v156, v157
    v_cvt_pk_bf16_f32 v119, v158, v159
    global_store_dwordx4 v11, v[116:119], s[18:19] offset:3072 sc1
    v_min3_u32 v12, v122, v123, v12
    v_max3_u32 v13, v122, v123, v13
    v_fma_f32 v14, v127, 0, v14
    v_cmp_gt_u32 vcc, 0x5a800000, v12
    s_nop 1
    v_cndmask_b32 v8, v8, 1, vcc
    v_cmp_lt_u32 vcc, 0x73800000, v13
    s_nop 1
    v_cndmask_b32 v8, v8, 1, vcc
    v_cmp_u_f32 vcc, v14, v14
    s_nop 1
    v_cndmask_b32 v8, v8, 1, vcc
    v_cmp_ne_u32 vcc, 0, v8
    s_nop 0
    s_or_b32 s26, vcc_lo, vcc_hi
    s_lshl_b32 s27, s22, 2
    s_add_u32 s27, s27, 123136
    v_mov_b32 v32, s26
    v_mov_b32 v33, s27
    v_mov_b32 v34, 123136
    ds_write_b32 v33, v32
    s_waitcnt lgkmcnt(0)
    s_barrier
    ds_read_b128 v[36:39], v34
    s_waitcnt lgkmcnt(0)
    v_or_b32 v36, v36, v37
    v_or3_b32 v36, v36, v38, v39
    s_nop 0
    v_readfirstlane_b32 s26, v36
    s_nop 0
    s_cmp_lg_u32 s26, 0
    s_cbranch_scc1 L_careful
    s_endpgm
L_careful:
    s_waitcnt vmcnt(0) lgkmcnt(0)
    v_and_b32 v12, 3, v0
    v_lshlrev_b32 v12, 10, v12
    v_bfe_u32 v13, v0, 2, 2
    v_lshl_add_u32 v12, v13, 8, v12
    v_bfe_u32 v13, v0, 4, 1
    v_lshl_add_u32 v12, v13, 7, v12
    v_bfe_u32 v13, v0, 5, 1
    v_lshl_add_u32 v12, v13, 4, v12
    v_lshrrev_b32 v13, 6, v0
    v_lshl_add_u32 v12, v13, 14, v12
    v_add_u32 v10, 0x1000, v12
    v_add_u32 v11, 0x3000, v12
    global_load_dwordx4 v[64:67], v10, s[4:5] offset:-4096
    global_load_dwordx4 v[68:71], v10, s[4:5] offset:-4064
    global_load_dwordx4 v[72:75], v10, s[4:5] offset:-4032
    global_load_dwordx4 v[76:79], v10, s[4:5] offset:-4000
    global_load_dwordx4 v[80:83], v10, s[4:5] offset:0
    global_load_dwordx4 v[84:87], v10, s[4:5] offset:32
    global_load_dwordx4 v[88:91], v10, s[4:5] offset:64
    global_load_dwordx4 v[92:95], v10, s[4:5] offset:96
    global_load_dwordx4 v[96:99], v11, s[4:5] offset:-4096
    global_load_dwordx4 v[100:103], v11, s[4:5] offset:-4064
    global_load_dwordx4 v[104:107], v11, s[4:5] offset:-4032
    global_load_dwordx4 v[108:111], v11, s[4:5] offset:-4000
    global_load_dwordx4 v[112:115], v11, s[4:5] offset:0
    global_load_dwordx4 v[116:119], v11, s[4:5] offset:32
    global_load_dwordx4 v[120:123], v11, s[4:5] offset:64
    global_load_dwordx4 v[124:127], v11, s[4:5] offset:96
    s_mov_b32 s34, 0
    s_mov_b32 s36, 0x3e0293ee
    s_mov_b32 s37, 0xffff0000
    s_waitcnt vmcnt(0)
    v_permlane32_swap_b32 v64, v65
    v_permlane32_swap_b32 v66, v67
    v_accvgpr_write_b32 a144, v64
    v_accvgpr_write_b32 a145, v66
    v_accvgpr_write_b32 a146, v65
    v_accvgpr_write_b32 a147, v67
    v_permlane32_swap_b32 v68, v69
    v_permlane32_swap_b32 v70, v71
    v_accvgpr_write_b32 a148, v68
    v_accvgpr_write_b32 a149, v70
    v_accvgpr_write_b32 a150, v69
    v_accvgpr_write_b32 a151, v71
    v_permlane32_swap_b32 v72, v73
    v_permlane32_swap_b32 v74, v75
    v_accvgpr_write_b32 a152, v72
    v_accvgpr_write_b32 a153, v74
    v_accvgpr_write_b32 a154, v73
    v_accvgpr_write_b32 a155, v75
    v_permlane32_swap_b32 v76, v77
    v_permlane32_swap_b32 v78, v79
    v_accvgpr_write_b32 a156, v76
    v_accvgpr_write_b32 a157, v78
    v_accvgpr_write_b32 a158, v77
    v_accvgpr_write_b32 a159, v79
    v_permlane32_swap_b32 v80, v81
    v_permlane32_swap_b32 v82, v83
    v_accvgpr_write_b32 a160, v80
    v_accvgpr_write_b32 a161, v82
    v_accvgpr_write_b32 a162, v81
    v_accvgpr_write_b32 a163, v83
    v_permlane32_swap_b32 v84, v85
    v_permlane32_swap_b32 v86, v87
    v_accvgpr_write_b32 a164, v84
    v_accvgpr_write_b32 a165, v86
    v_accvgpr_write_b32 a166, v85
    v_accvgpr_write_b32 a167, v87
    v_permlane32_swap_b32 v88, v89
    v_permlane32_swap_b32 v90, v91
    v_accvgpr_write_b32 a168, v88
    v_accvgpr_write_b32 a169, v90
    v_accvgpr_write_b32 a170, v89
    v_accvgpr_write_b32 a171, v91
    v_permlane32_swap_b32 v92, v93
    v_permlane32_swap_b32 v94, v95
    v_accvgpr_write_b32 a172, v92
    v_accvgpr_write_b32 a173, v94
    v_accvgpr_write_b32 a174, v93
    v_accvgpr_write_b32 a175, v95
    v_permlane32_swap_b32 v96, v97
    v_permlane32_swap_b32 v98, v99
    v_accvgpr_write_b32 a176, v96
    v_accvgpr_write_b32 a177, v98
    v_accvgpr_write_b32 a178, v97
    v_accvgpr_write_b32 a179, v99
    v_permlane32_swap_b32 v100, v101
    v_permlane32_swap_b32 v102, v103
    v_accvgpr_write_b32 a180, v100
    v_accvgpr_write_b32 a181, v102
    v_accvgpr_write_b32 a182, v101
    v_accvgpr_write_b32 a183, v103
    v_permlane32_swap_b32 v104, v105
    v_permlane32_swap_b32 v106, v107
    v_accvgpr_write_b32 a184, v104
    v_accvgpr_write_b32 a185, v106
    v_accvgpr_write_b32 a186, v105
    v_accvgpr_write_b32 a187, v107
    v_permlane32_swap_b32 v108, v109
    v_permlane32_swap_b32 v110, v111
    v_accvgpr_write_b32 a188, v108
    v_accvgpr_write_b32 a189, v110
    v_accvgpr_write_b32 a190, v109
    v_accvgpr_write_b32 a191, v111
    v_permlane32_swap_b32 v112, v113
    v_permlane32_swap_b32 v114, v115
    v_accvgpr_write_b32 a192, v112
    v_accvgpr_write_b32 a193, v114
    v_accvgpr_write_b32 a194, v113
    v_accvgpr_write_b32 a195, v115
    v_permlane32_swap_b32 v116, v117
    v_permlane32_swap_b32 v118, v119
    v_accvgpr_write_b32 a196, v116
    v_accvgpr_write_b32 a197, v118
    v_accvgpr_write_b32 a198, v117
    v_accvgpr_write_b32 a199, v119
    v_permlane32_swap_b32 v120, v121
    v_permlane32_swap_b32 v122, v123
    v_accvgpr_write_b32 a200, v120
    v_accvgpr_write_b32 a201, v122
    v_accvgpr_write_b32 a202, v121
    v_accvgpr_write_b32 a203, v123
    v_permlane32_swap_b32 v124, v125
    v_permlane32_swap_b32 v126, v127
    v_accvgpr_write_b32 a204, v124
    v_accvgpr_write_b32 a205, v126
    v_accvgpr_write_b32 a206, v125
    v_accvgpr_write_b32 a207, v127
    v_accvgpr_write_b32 a0, 0
    v_accvgpr_write_b32 a1, 0
    v_accvgpr_write_b32 a2, 0
    v_accvgpr_write_b32 a3, 0
    v_accvgpr_write_b32 a4, 0
    v_accvgpr_write_b32 a5, 0
    v_accvgpr_write_b32 a6, 0
    v_accvgpr_write_b32 a7, 0
    v_accvgpr_write_b32 a8, 0
    v_accvgpr_write_b32 a9, 0
    v_accvgpr_write_b32 a10, 0
    v_accvgpr_write_b32 a11, 0
    v_accvgpr_write_b32 a12, 0
    v_accvgpr_write_b32 a13, 0
    v_accvgpr_write_b32 a14, 0
    v_accvgpr_write_b32 a15, 0
    v_accvgpr_write_b32 a16, 0
    v_accvgpr_write_b32 a17, 0
    v_accvgpr_write_b32 a18, 0
    v_accvgpr_write_b32 a19, 0
    v_accvgpr_write_b32 a20, 0
    v_accvgpr_write_b32 a21, 0
    v_accvgpr_write_b32 a22, 0
    v_accvgpr_write_b32 a23, 0
    v_accvgpr_write_b32 a24, 0
    v_accvgpr_write_b32 a25, 0
    v_accvgpr_write_b32 a26, 0
    v_accvgpr_write_b32 a27, 0
    v_accvgpr_write_b32 a28, 0
    v_accvgpr_write_b32 a29, 0
    v_accvgpr_write_b32 a30, 0
    v_accvgpr_write_b32 a31, 0
    v_accvgpr_write_b32 a32, 0
    v_accvgpr_write_b32 a33, 0
    v_accvgpr_write_b32 a34, 0
    v_accvgpr_write_b32 a35, 0
    v_accvgpr_write_b32 a36, 0
    v_accvgpr_write_b32 a37, 0
    v_accvgpr_write_b32 a38, 0
    v_accvgpr_write_b32 a39, 0
    v_accvgpr_write_b32 a40, 0
    v_accvgpr_write_b32 a41, 0
    v_accvgpr_write_b32 a42, 0
    v_accvgpr_write_b32 a43, 0
    v_accvgpr_write_b32 a44, 0
    v_accvgpr_write_b32 a45, 0
    v_accvgpr_write_b32 a46, 0
    v_accvgpr_write_b32 a47, 0
    v_accvgpr_write_b32 a48, 0
    v_accvgpr_write_b32 a49, 0
    v_accvgpr_write_b32 a50, 0
    v_accvgpr_write_b32 a51, 0
    v_accvgpr_write_b32 a52, 0
    v_accvgpr_write_b32 a53, 0
    v_accvgpr_write_b32 a54, 0
    v_accvgpr_write_b32 a55, 0
    v_accvgpr_write_b32 a56, 0
    v_accvgpr_write_b32 a57, 0
    v_accvgpr_write_b32 a58, 0
    v_accvgpr_write_b32 a59, 0
    v_accvgpr_write_b32 a60, 0
    v_accvgpr_write_b32 a61, 0
    v_accvgpr_write_b32 a62, 0
    v_accvgpr_write_b32 a63, 0
    v_accvgpr_write_b32 a64, 0
    v_accvgpr_write_b32 a65, 0
    v_accvgpr_write_b32 a66, 0
    v_accvgpr_write_b32 a67, 0
    v_accvgpr_write_b32 a68, 0
    v_accvgpr_write_b32 a69, 0
    v_accvgpr_write_b32 a70, 0
    v_accvgpr_write_b32 a71, 0
    v_accvgpr_write_b32 a72, 0
    v_accvgpr_write_b32 a73, 0
    v_accvgpr_write_b32 a74, 0
    v_accvgpr_write_b32 a75, 0
    v_accvgpr_write_b32 a76, 0
    v_accvgpr_write_b32 a77, 0
    v_accvgpr_write_b32 a78, 0
    v_accvgpr_write_b32 a79, 0
    v_accvgpr_write_b32 a80, 0
    v_accvgpr_write_b32 a81, 0
    v_accvgpr_write_b32 a82, 0
    v_accvgpr_write_b32 a83, 0
    v_accvgpr_write_b32 a84, 0
    v_accvgpr_write_b32 a85, 0
    v_accvgpr_write_b32 a86, 0
    v_accvgpr_write_b32 a87, 0
    v_accvgpr_write_b32 a88, 0
    v_accvgpr_write_b32 a89, 0
    v_accvgpr_write_b32 a90, 0
    v_accvgpr_write_b32 a91, 0
    v_accvgpr_write_b32 a92, 0
    v_accvgpr_write_b32 a93, 0
    v_accvgpr_write_b32 a94, 0
    v_accvgpr_write_b32 a95, 0
    v_accvgpr_write_b32 a96, 0
    v_accvgpr_write_b32 a97, 0
    v_accvgpr_write_b32 a98, 0
    v_accvgpr_write_b32 a99, 0
    v_accvgpr_write_b32 a100, 0
    v_accvgpr_write_b32 a101, 0
    v_accvgpr_write_b32 a102, 0
    v_accvgpr_write_b32 a103, 0
    v_accvgpr_write_b32 a104, 0
    v_accvgpr_write_b32 a105, 0
    v_accvgpr_write_b32 a106, 0
    v_accvgpr_write_b32 a107, 0
    v_accvgpr_write_b32 a108, 0
    v_accvgpr_write_b32 a109, 0
    v_accvgpr_write_b32 a110, 0
    v_accvgpr_write_b32 a111, 0
    v_accvgpr_write_b32 a112, 0
    v_accvgpr_write_b32 a113, 0
    v_accvgpr_write_b32 a114, 0
    v_accvgpr_write_b32 a115, 0
    v_accvgpr_write_b32 a116, 0
    v_accvgpr_write_b32 a117, 0
    v_accvgpr_write_b32 a118, 0
    v_accvgpr_write_b32 a119, 0
    v_accvgpr_write_b32 a120, 0
    v_accvgpr_write_b32 a121, 0
    v_accvgpr_write_b32 a122, 0
    v_accvgpr_write_b32 a123, 0
    v_accvgpr_write_b32 a124, 0
    v_accvgpr_write_b32 a125, 0
    v_accvgpr_write_b32 a126, 0
    v_accvgpr_write_b32 a127, 0
    v_accvgpr_write_b32 a128, 0
    v_accvgpr_write_b32 a129, 0
    v_accvgpr_write_b32 a130, 0
    v_accvgpr_write_b32 a131, 0
    v_accvgpr_write_b32 a132, 0
    v_accvgpr_write_b32 a133, 0
    v_accvgpr_write_b32 a134, 0
    v_accvgpr_write_b32 a135, 0
    v_accvgpr_write_b32 a136, 0
    v_accvgpr_write_b32 a137, 0
    v_accvgpr_write_b32 a138, 0
    v_accvgpr_write_b32 a139, 0
    v_accvgpr_write_b32 a140, 0
    v_accvgpr_write_b32 a141, 0
    v_accvgpr_write_b32 a142, 0
    v_accvgpr_write_b32 a143, 0
    v_mov_b32 v44, 0xff800000
    v_mov_b32 v56, 0x3f803f80
    v_mov_b32 v45, 0xff800000
    v_mov_b32 v57, 0x3f803f80
    v_mov_b32 v46, 0xff800000
    v_mov_b32 v58, 0x3f803f80
    v_mov_b32 v47, 0xff800000
    v_mov_b32 v59, 0x3f803f80
    s_nop 7
L_c_pass:
    s_mov_b32 s35, 0
    s_mov_b64 s[38:39], s[28:29]
    s_mov_b64 s[40:41], s[30:31]
    v_and_b32 v48, 31, v0
    v_lshlrev_b32 v48, 3, v48
    v_lshrrev_b32 v49, 5, v0
    v_lshlrev_b32 v49, 4, v49
L_c_tile:
    global_load_dwordx4 v[160:163], v1, s[38:39] offset:0
    global_load_dwordx4 v[192:195], v1, s[40:41] offset:0
    global_load_dwordx4 v[164:167], v1, s[38:39] offset:512
    global_load_dwordx4 v[196:199], v1, s[40:41] offset:512
    global_load_dwordx4 v[168:171], v1, s[38:39] offset:1024
    global_load_dwordx4 v[200:203], v1, s[40:41] offset:1024
    global_load_dwordx4 v[172:175], v1, s[38:39] offset:1536
    global_load_dwordx4 v[204:207], v1, s[40:41] offset:1536
    global_load_dwordx4 v[176:179], v1, s[38:39] offset:2048
    global_load_dwordx4 v[208:211], v1, s[40:41] offset:2048
    global_load_dwordx4 v[180:183], v1, s[38:39] offset:2560
    global_load_dwordx4 v[212:215], v1, s[40:41] offset:2560
    global_load_dwordx4 v[184:187], v1, s[38:39] offset:3072
    global_load_dwordx4 v[216:219], v1, s[40:41] offset:3072
    global_load_dwordx4 v[188:191], v1, s[38:39] offset:3584
    global_load_dwordx4 v[220:223], v1, s[40:41] offset:3584
    global_load_dwordx2 v[16:17], v48, s[10:11]
    global_load_dwordx2 v[18:19], v48, s[12:13]
    global_load_dwordx4 v[20:23], v49, s[14:15]
    global_load_dwordx4 v[24:27], v49, s[16:17]
    s_add_u32 s38, s38, 0x8000
    s_addc_u32 s39, s39, 0
    s_add_u32 s40, s40, 0x8000
    s_addc_u32 s41, s41, 0
    v_add_u32 v48, 256, v48
    v_add_u32 v49, 128, v49
    s_waitcnt vmcnt(0)
    v_lshlrev_b32 v28, 16, v16
    v_and_b32 v29, s37, v16
    v_lshlrev_b32 v32, 16, v18
    v_and_b32 v33, s37, v18
    v_lshlrev_b32 v30, 16, v17
    v_and_b32 v31, s37, v17
    v_lshlrev_b32 v34, 16, v19
    v_and_b32 v35, s37, v19
    v_cvt_f32_i32 v160, v160
    v_cvt_f32_i32 v161, v161
    v_cvt_pk_bf16_f32 v161, v160, v161
    v_lshlrev_b32 v160, 16, v161
    v_and_b32 v161, s37, v161
    v_sub_f32 v160, v160, v32
    v_sub_f32 v161, v161, v33
    v_cvt_pk_bf16_f32 v161, v160, v161
    v_lshlrev_b32 v160, 16, v161
    v_and_b32 v161, s37, v161
    v_mul_f32 v160, v160, v28
    v_mul_f32 v161, v161, v29
    v_cvt_pk_bf16_f32 v160, v160, v161
    v_cvt_f32_i32 v162, v162
    v_cvt_f32_i32 v163, v163
    v_cvt_pk_bf16_f32 v163, v162, v163
    v_lshlrev_b32 v162, 16, v163
    v_and_b32 v163, s37, v163
    v_sub_f32 v162, v162, v34
    v_sub_f32 v163, v163, v35
    v_cvt_pk_bf16_f32 v163, v162, v163
    v_lshlrev_b32 v162, 16, v163
    v_and_b32 v163, s37, v163
    v_mul_f32 v162, v162, v30
    v_mul_f32 v163, v163, v31
    v_cvt_pk_bf16_f32 v162, v162, v163
    v_cvt_f32_i32 v164, v164
    v_cvt_f32_i32 v165, v165
    v_cvt_pk_bf16_f32 v165, v164, v165
    v_lshlrev_b32 v164, 16, v165
    v_and_b32 v165, s37, v165
    v_sub_f32 v164, v164, v32
    v_sub_f32 v165, v165, v33
    v_cvt_pk_bf16_f32 v165, v164, v165
    v_lshlrev_b32 v164, 16, v165
    v_and_b32 v165, s37, v165
    v_mul_f32 v164, v164, v28
    v_mul_f32 v165, v165, v29
    v_cvt_pk_bf16_f32 v164, v164, v165
    v_cvt_f32_i32 v166, v166
    v_cvt_f32_i32 v167, v167
    v_cvt_pk_bf16_f32 v167, v166, v167
    v_lshlrev_b32 v166, 16, v167
    v_and_b32 v167, s37, v167
    v_sub_f32 v166, v166, v34
    v_sub_f32 v167, v167, v35
    v_cvt_pk_bf16_f32 v167, v166, v167
    v_lshlrev_b32 v166, 16, v167
    v_and_b32 v167, s37, v167
    v_mul_f32 v166, v166, v30
    v_mul_f32 v167, v167, v31
    v_cvt_pk_bf16_f32 v166, v166, v167
    v_cvt_f32_i32 v168, v168
    v_cvt_f32_i32 v169, v169
    v_cvt_pk_bf16_f32 v169, v168, v169
    v_lshlrev_b32 v168, 16, v169
    v_and_b32 v169, s37, v169
    v_sub_f32 v168, v168, v32
    v_sub_f32 v169, v169, v33
    v_cvt_pk_bf16_f32 v169, v168, v169
    v_lshlrev_b32 v168, 16, v169
    v_and_b32 v169, s37, v169
    v_mul_f32 v168, v168, v28
    v_mul_f32 v169, v169, v29
    v_cvt_pk_bf16_f32 v168, v168, v169
    v_cvt_f32_i32 v170, v170
    v_cvt_f32_i32 v171, v171
    v_cvt_pk_bf16_f32 v171, v170, v171
    v_lshlrev_b32 v170, 16, v171
    v_and_b32 v171, s37, v171
    v_sub_f32 v170, v170, v34
    v_sub_f32 v171, v171, v35
    v_cvt_pk_bf16_f32 v171, v170, v171
    v_lshlrev_b32 v170, 16, v171
    v_and_b32 v171, s37, v171
    v_mul_f32 v170, v170, v30
    v_mul_f32 v171, v171, v31
    v_cvt_pk_bf16_f32 v170, v170, v171
    v_cvt_f32_i32 v172, v172
    v_cvt_f32_i32 v173, v173
    v_cvt_pk_bf16_f32 v173, v172, v173
    v_lshlrev_b32 v172, 16, v173
    v_and_b32 v173, s37, v173
    v_sub_f32 v172, v172, v32
    v_sub_f32 v173, v173, v33
    v_cvt_pk_bf16_f32 v173, v172, v173
    v_lshlrev_b32 v172, 16, v173
    v_and_b32 v173, s37, v173
    v_mul_f32 v172, v172, v28
    v_mul_f32 v173, v173, v29
    v_cvt_pk_bf16_f32 v172, v172, v173
    v_cvt_f32_i32 v174, v174
    v_cvt_f32_i32 v175, v175
    v_cvt_pk_bf16_f32 v175, v174, v175
    v_lshlrev_b32 v174, 16, v175
    v_and_b32 v175, s37, v175
    v_sub_f32 v174, v174, v34
    v_sub_f32 v175, v175, v35
    v_cvt_pk_bf16_f32 v175, v174, v175
    v_lshlrev_b32 v174, 16, v175
    v_and_b32 v175, s37, v175
    v_mul_f32 v174, v174, v30
    v_mul_f32 v175, v175, v31
    v_cvt_pk_bf16_f32 v174, v174, v175
    v_cvt_f32_i32 v176, v176
    v_cvt_f32_i32 v177, v177
    v_cvt_pk_bf16_f32 v177, v176, v177
    v_lshlrev_b32 v176, 16, v177
    v_and_b32 v177, s37, v177
    v_sub_f32 v176, v176, v32
    v_sub_f32 v177, v177, v33
    v_cvt_pk_bf16_f32 v177, v176, v177
    v_lshlrev_b32 v176, 16, v177
    v_and_b32 v177, s37, v177
    v_mul_f32 v176, v176, v28
    v_mul_f32 v177, v177, v29
    v_cvt_pk_bf16_f32 v176, v176, v177
    v_cvt_f32_i32 v178, v178
    v_cvt_f32_i32 v179, v179
    v_cvt_pk_bf16_f32 v179, v178, v179
    v_lshlrev_b32 v178, 16, v179
    v_and_b32 v179, s37, v179
    v_sub_f32 v178, v178, v34
    v_sub_f32 v179, v179, v35
    v_cvt_pk_bf16_f32 v179, v178, v179
    v_lshlrev_b32 v178, 16, v179
    v_and_b32 v179, s37, v179
    v_mul_f32 v178, v178, v30
    v_mul_f32 v179, v179, v31
    v_cvt_pk_bf16_f32 v178, v178, v179
    v_cvt_f32_i32 v180, v180
    v_cvt_f32_i32 v181, v181
    v_cvt_pk_bf16_f32 v181, v180, v181
    v_lshlrev_b32 v180, 16, v181
    v_and_b32 v181, s37, v181
    v_sub_f32 v180, v180, v32
    v_sub_f32 v181, v181, v33
    v_cvt_pk_bf16_f32 v181, v180, v181
    v_lshlrev_b32 v180, 16, v181
    v_and_b32 v181, s37, v181
    v_mul_f32 v180, v180, v28
    v_mul_f32 v181, v181, v29
    v_cvt_pk_bf16_f32 v180, v180, v181
    v_cvt_f32_i32 v182, v182
    v_cvt_f32_i32 v183, v183
    v_cvt_pk_bf16_f32 v183, v182, v183
    v_lshlrev_b32 v182, 16, v183
    v_and_b32 v183, s37, v183
    v_sub_f32 v182, v182, v34
    v_sub_f32 v183, v183, v35
    v_cvt_pk_bf16_f32 v183, v182, v183
    v_lshlrev_b32 v182, 16, v183
    v_and_b32 v183, s37, v183
    v_mul_f32 v182, v182, v30
    v_mul_f32 v183, v183, v31
    v_cvt_pk_bf16_f32 v182, v182, v183
    v_cvt_f32_i32 v184, v184
    v_cvt_f32_i32 v185, v185
    v_cvt_pk_bf16_f32 v185, v184, v185
    v_lshlrev_b32 v184, 16, v185
    v_and_b32 v185, s37, v185
    v_sub_f32 v184, v184, v32
    v_sub_f32 v185, v185, v33
    v_cvt_pk_bf16_f32 v185, v184, v185
    v_lshlrev_b32 v184, 16, v185
    v_and_b32 v185, s37, v185
    v_mul_f32 v184, v184, v28
    v_mul_f32 v185, v185, v29
    v_cvt_pk_bf16_f32 v184, v184, v185
    v_cvt_f32_i32 v186, v186
    v_cvt_f32_i32 v187, v187
    v_cvt_pk_bf16_f32 v187, v186, v187
    v_lshlrev_b32 v186, 16, v187
    v_and_b32 v187, s37, v187
    v_sub_f32 v186, v186, v34
    v_sub_f32 v187, v187, v35
    v_cvt_pk_bf16_f32 v187, v186, v187
    v_lshlrev_b32 v186, 16, v187
    v_and_b32 v187, s37, v187
    v_mul_f32 v186, v186, v30
    v_mul_f32 v187, v187, v31
    v_cvt_pk_bf16_f32 v186, v186, v187
    v_cvt_f32_i32 v188, v188
    v_cvt_f32_i32 v189, v189
    v_cvt_pk_bf16_f32 v189, v188, v189
    v_lshlrev_b32 v188, 16, v189
    v_and_b32 v189, s37, v189
    v_sub_f32 v188, v188, v32
    v_sub_f32 v189, v189, v33
    v_cvt_pk_bf16_f32 v189, v188, v189
    v_lshlrev_b32 v188, 16, v189
    v_and_b32 v189, s37, v189
    v_mul_f32 v188, v188, v28
    v_mul_f32 v189, v189, v29
    v_cvt_pk_bf16_f32 v188, v188, v189
    v_cvt_f32_i32 v190, v190
    v_cvt_f32_i32 v191, v191
    v_cvt_pk_bf16_f32 v191, v190, v191
    v_lshlrev_b32 v190, 16, v191
    v_and_b32 v191, s37, v191
    v_sub_f32 v190, v190, v34
    v_sub_f32 v191, v191, v35
    v_cvt_pk_bf16_f32 v191, v190, v191
    v_lshlrev_b32 v190, 16, v191
    v_and_b32 v191, s37, v191
    v_mul_f32 v190, v190, v30
    v_mul_f32 v191, v191, v31
    v_cvt_pk_bf16_f32 v190, v190, v191
    v_lshlrev_b32 v28, 16, v20
    v_and_b32 v29, s37, v20
    v_lshlrev_b32 v36, 16, v24
    v_and_b32 v37, s37, v24
    v_lshlrev_b32 v30, 16, v21
    v_and_b32 v31, s37, v21
    v_lshlrev_b32 v38, 16, v25
    v_and_b32 v39, s37, v25
    v_lshlrev_b32 v32, 16, v22
    v_and_b32 v33, s37, v22
    v_lshlrev_b32 v40, 16, v26
    v_and_b32 v41, s37, v26
    v_lshlrev_b32 v34, 16, v23
    v_and_b32 v35, s37, v23
    v_lshlrev_b32 v42, 16, v27
    v_and_b32 v43, s37, v27
    v_cvt_f32_i32 v192, v192
    v_cvt_f32_i32 v196, v196
    v_cvt_pk_bf16_f32 v196, v192, v196
    v_lshlrev_b32 v192, 16, v196
    v_and_b32 v196, s37, v196
    v_sub_f32 v192, v192, v36
    v_sub_f32 v196, v196, v37
    v_cvt_pk_bf16_f32 v196, v192, v196
    v_lshlrev_b32 v192, 16, v196
    v_and_b32 v196, s37, v196
    v_mul_f32 v192, v192, v28
    v_mul_f32 v196, v196, v29
    v_cvt_pk_bf16_f32 v224, v192, v196
    v_cvt_f32_i32 v193, v193
    v_cvt_f32_i32 v197, v197
    v_cvt_pk_bf16_f32 v197, v193, v197
    v_lshlrev_b32 v193, 16, v197
    v_and_b32 v197, s37, v197
    v_sub_f32 v193, v193, v36
    v_sub_f32 v197, v197, v37
    v_cvt_pk_bf16_f32 v197, v193, v197
    v_lshlrev_b32 v193, 16, v197
    v_and_b32 v197, s37, v197
    v_mul_f32 v193, v193, v28
    v_mul_f32 v197, v197, v29
    v_cvt_pk_bf16_f32 v228, v193, v197
    v_cvt_f32_i32 v194, v194
    v_cvt_f32_i32 v198, v198
    v_cvt_pk_bf16_f32 v198, v194, v198
    v_lshlrev_b32 v194, 16, v198
    v_and_b32 v198, s37, v198
    v_sub_f32 v194, v194, v36
    v_sub_f32 v198, v198, v37
    v_cvt_pk_bf16_f32 v198, v194, v198
    v_lshlrev_b32 v194, 16, v198
    v_and_b32 v198, s37, v198
    v_mul_f32 v194, v194, v28
    v_mul_f32 v198, v198, v29
    v_cvt_pk_bf16_f32 v232, v194, v198
    v_cvt_f32_i32 v195, v195
    v_cvt_f32_i32 v199, v199
    v_cvt_pk_bf16_f32 v199, v195, v199
    v_lshlrev_b32 v195, 16, v199
    v_and_b32 v199, s37, v199
    v_sub_f32 v195, v195, v36
    v_sub_f32 v199, v199, v37
    v_cvt_pk_bf16_f32 v199, v195, v199
    v_lshlrev_b32 v195, 16, v199
    v_and_b32 v199, s37, v199
    v_mul_f32 v195, v195, v28
    v_mul_f32 v199, v199, v29
    v_cvt_pk_bf16_f32 v236, v195, v199
    v_cvt_f32_i32 v200, v200
    v_cvt_f32_i32 v204, v204
    v_cvt_pk_bf16_f32 v204, v200, v204
    v_lshlrev_b32 v200, 16, v204
    v_and_b32 v204, s37, v204
    v_sub_f32 v200, v200, v38
    v_sub_f32 v204, v204, v39
    v_cvt_pk_bf16_f32 v204, v200, v204
    v_lshlrev_b32 v200, 16, v204
    v_and_b32 v204, s37, v204
    v_mul_f32 v200, v200, v30
    v_mul_f32 v204, v204, v31
    v_cvt_pk_bf16_f32 v225, v200, v204
    v_cvt_f32_i32 v201, v201
    v_cvt_f32_i32 v205, v205
    v_cvt_pk_bf16_f32 v205, v201, v205
    v_lshlrev_b32 v201, 16, v205
    v_and_b32 v205, s37, v205
    v_sub_f32 v201, v201, v38
    v_sub_f32 v205, v205, v39
    v_cvt_pk_bf16_f32 v205, v201, v205
    v_lshlrev_b32 v201, 16, v205
    v_and_b32 v205, s37, v205
    v_mul_f32 v201, v201, v30
    v_mul_f32 v205, v205, v31
    v_cvt_pk_bf16_f32 v229, v201, v205
    v_cvt_f32_i32 v202, v202
    v_cvt_f32_i32 v206, v206
    v_cvt_pk_bf16_f32 v206, v202, v206
    v_lshlrev_b32 v202, 16, v206
    v_and_b32 v206, s37, v206
    v_sub_f32 v202, v202, v38
    v_sub_f32 v206, v206, v39
    v_cvt_pk_bf16_f32 v206, v202, v206
    v_lshlrev_b32 v202, 16, v206
    v_and_b32 v206, s37, v206
    v_mul_f32 v202, v202, v30
    v_mul_f32 v206, v206, v31
    v_cvt_pk_bf16_f32 v233, v202, v206
    v_cvt_f32_i32 v203, v203
    v_cvt_f32_i32 v207, v207
    v_cvt_pk_bf16_f32 v207, v203, v207
    v_lshlrev_b32 v203, 16, v207
    v_and_b32 v207, s37, v207
    v_sub_f32 v203, v203, v38
    v_sub_f32 v207, v207, v39
    v_cvt_pk_bf16_f32 v207, v203, v207
    v_lshlrev_b32 v203, 16, v207
    v_and_b32 v207, s37, v207
    v_mul_f32 v203, v203, v30
    v_mul_f32 v207, v207, v31
    v_cvt_pk_bf16_f32 v237, v203, v207
    v_cvt_f32_i32 v208, v208
    v_cvt_f32_i32 v212, v212
    v_cvt_pk_bf16_f32 v212, v208, v212
    v_lshlrev_b32 v208, 16, v212
    v_and_b32 v212, s37, v212
    v_sub_f32 v208, v208, v40
    v_sub_f32 v212, v212, v41
    v_cvt_pk_bf16_f32 v212, v208, v212
    v_lshlrev_b32 v208, 16, v212
    v_and_b32 v212, s37, v212
    v_mul_f32 v208, v208, v32
    v_mul_f32 v212, v212, v33
    v_cvt_pk_bf16_f32 v226, v208, v212
    v_cvt_f32_i32 v209, v209
    v_cvt_f32_i32 v213, v213
    v_cvt_pk_bf16_f32 v213, v209, v213
    v_lshlrev_b32 v209, 16, v213
    v_and_b32 v213, s37, v213
    v_sub_f32 v209, v209, v40
    v_sub_f32 v213, v213, v41
    v_cvt_pk_bf16_f32 v213, v209, v213
    v_lshlrev_b32 v209, 16, v213
    v_and_b32 v213, s37, v213
    v_mul_f32 v209, v209, v32
    v_mul_f32 v213, v213, v33
    v_cvt_pk_bf16_f32 v230, v209, v213
    v_cvt_f32_i32 v210, v210
    v_cvt_f32_i32 v214, v214
    v_cvt_pk_bf16_f32 v214, v210, v214
    v_lshlrev_b32 v210, 16, v214
    v_and_b32 v214, s37, v214
    v_sub_f32 v210, v210, v40
    v_sub_f32 v214, v214, v41
    v_cvt_pk_bf16_f32 v214, v210, v214
    v_lshlrev_b32 v210, 16, v214
    v_and_b32 v214, s37, v214
    v_mul_f32 v210, v210, v32
    v_mul_f32 v214, v214, v33
    v_cvt_pk_bf16_f32 v234, v210, v214
    v_cvt_f32_i32 v211, v211
    v_cvt_f32_i32 v215, v215
    v_cvt_pk_bf16_f32 v215, v211, v215
    v_lshlrev_b32 v211, 16, v215
    v_and_b32 v215, s37, v215
    v_sub_f32 v211, v211, v40
    v_sub_f32 v215, v215, v41
    v_cvt_pk_bf16_f32 v215, v211, v215
    v_lshlrev_b32 v211, 16, v215
    v_and_b32 v215, s37, v215
    v_mul_f32 v211, v211, v32
    v_mul_f32 v215, v215, v33
    v_cvt_pk_bf16_f32 v238, v211, v215
    v_cvt_f32_i32 v216, v216
    v_cvt_f32_i32 v220, v220
    v_cvt_pk_bf16_f32 v220, v216, v220
    v_lshlrev_b32 v216, 16, v220
    v_and_b32 v220, s37, v220
    v_sub_f32 v216, v216, v42
    v_sub_f32 v220, v220, v43
    v_cvt_pk_bf16_f32 v220, v216, v220
    v_lshlrev_b32 v216, 16, v220
    v_and_b32 v220, s37, v220
    v_mul_f32 v216, v216, v34
    v_mul_f32 v220, v220, v35
    v_cvt_pk_bf16_f32 v227, v216, v220
    v_cvt_f32_i32 v217, v217
    v_cvt_f32_i32 v221, v221
    v_cvt_pk_bf16_f32 v221, v217, v221
    v_lshlrev_b32 v217, 16, v221
    v_and_b32 v221, s37, v221
    v_sub_f32 v217, v217, v42
    v_sub_f32 v221, v221, v43
    v_cvt_pk_bf16_f32 v221, v217, v221
    v_lshlrev_b32 v217, 16, v221
    v_and_b32 v221, s37, v221
    v_mul_f32 v217, v217, v34
    v_mul_f32 v221, v221, v35
    v_cvt_pk_bf16_f32 v231, v217, v221
    v_cvt_f32_i32 v218, v218
    v_cvt_f32_i32 v222, v222
    v_cvt_pk_bf16_f32 v222, v218, v222
    v_lshlrev_b32 v218, 16, v222
    v_and_b32 v222, s37, v222
    v_sub_f32 v218, v218, v42
    v_sub_f32 v222, v222, v43
    v_cvt_pk_bf16_f32 v222, v218, v222
    v_lshlrev_b32 v218, 16, v222
    v_and_b32 v222, s37, v222
    v_mul_f32 v218, v218, v34
    v_mul_f32 v222, v222, v35
    v_cvt_pk_bf16_f32 v235, v218, v222
    v_cvt_f32_i32 v219, v219
    v_cvt_f32_i32 v223, v223
    v_cvt_pk_bf16_f32 v223, v219, v223
    v_lshlrev_b32 v219, 16, v223
    v_and_b32 v223, s37, v223
    v_sub_f32 v219, v219, v42
    v_sub_f32 v223, v223, v43
    v_cvt_pk_bf16_f32 v223, v219, v223
    v_lshlrev_b32 v219, 16, v223
    v_and_b32 v223, s37, v223
    v_mul_f32 v219, v219, v34
    v_mul_f32 v223, v223, v35
    v_cvt_pk_bf16_f32 v239, v219, v223
    s_waitcnt lgkmcnt(0)
    s_barrier
    ds_write_addtid_b32 v160 offset:0
    ds_write_addtid_b32 v162 offset:1088
    ds_write_addtid_b32 v164 offset:272
    ds_write_addtid_b32 v166 offset:1360
    ds_write_addtid_b32 v168 offset:544
    ds_write_addtid_b32 v170 offset:1632
    ds_write_addtid_b32 v172 offset:816
    ds_write_addtid_b32 v174 offset:1904
    ds_write_addtid_b32 v176 offset:2176
    ds_write_addtid_b32 v178 offset:3264
    ds_write_addtid_b32 v180 offset:2448
    ds_write_addtid_b32 v182 offset:3536
    ds_write_addtid_b32 v184 offset:2720
    ds_write_addtid_b32 v186 offset:3808
    ds_write_addtid_b32 v188 offset:2992
    ds_write_addtid_b32 v190 offset:4080
    ds_write_b128 v4, v[224:227] offset:0
    ds_write_b128 v4, v[228:231] offset:2048
    ds_write_b128 v4, v[232:235] offset:4096
    ds_write_b128 v4, v[236:239] offset:6144
    s_waitcnt lgkmcnt(0)
    s_barrier
    ds_read_b128 a[208:211], v2 offset:0
    ds_read_b128 a[212:215], v2 offset:16
    ds_read_b128 a[216:219], v2 offset:32
    ds_read_b128 a[220:223], v2 offset:48
    s_waitcnt lgkmcnt(0)
    v_mfma_f32_16x16x32_bf16 v[64:67], a[208:211], a[144:147], 0
    v_mfma_f32_16x16x32_bf16 v[64:67], a[212:215], a[148:151], v[64:67]
    v_mfma_f32_16x16x32_bf16 v[64:67], a[216:219], a[152:155], v[64:67]
    v_mfma_f32_16x16x32_bf16 v[64:67], a[220:223], a[156:159], v[64:67]
    v_mfma_f32_16x16x32_bf16 v[80:83], a[208:211], a[160:163], 0
    v_mfma_f32_16x16x32_bf16 v[80:83], a[212:215], a[164:167], v[80:83]
    v_mfma_f32_16x16x32_bf16 v[80:83], a[216:219], a[168:171], v[80:83]
    v_mfma_f32_16x16x32_bf16 v[80:83], a[220:223], a[172:175], v[80:83]
    v_mfma_f32_16x16x32_bf16 v[96:99], a[208:211], a[176:179], 0
    v_mfma_f32_16x16x32_bf16 v[96:99], a[212:215], a[180:183], v[96:99]
    v_mfma_f32_16x16x32_bf16 v[96:99], a[216:219], a[184:187], v[96:99]
    v_mfma_f32_16x16x32_bf16 v[96:99], a[220:223], a[188:191], v[96:99]
    v_mfma_f32_16x16x32_bf16 v[112:115], a[208:211], a[192:195], 0
    v_mfma_f32_16x16x32_bf16 v[112:115], a[212:215], a[196:199], v[112:115]
    v_mfma_f32_16x16x32_bf16 v[112:115], a[216:219], a[200:203], v[112:115]
    v_mfma_f32_16x16x32_bf16 v[112:115], a[220:223], a[204:207], v[112:115]
    s_nop 7
    ds_read_b128 a[208:211], v2 offset:2176
    ds_read_b128 a[212:215], v2 offset:2192
    ds_read_b128 a[216:219], v2 offset:2208
    ds_read_b128 a[220:223], v2 offset:2224
    s_waitcnt lgkmcnt(0)
    v_mfma_f32_16x16x32_bf16 v[68:71], a[208:211], a[144:147], 0
    v_mfma_f32_16x16x32_bf16 v[68:71], a[212:215], a[148:151], v[68:71]
    v_mfma_f32_16x16x32_bf16 v[68:71], a[216:219], a[152:155], v[68:71]
    v_mfma_f32_16x16x32_bf16 v[68:71], a[220:223], a[156:159], v[68:71]
    v_mfma_f32_16x16x32_bf16 v[84:87], a[208:211], a[160:163], 0
    v_mfma_f32_16x16x32_bf16 v[84:87], a[212:215], a[164:167], v[84:87]
    v_mfma_f32_16x16x32_bf16 v[84:87], a[216:219], a[168:171], v[84:87]
    v_mfma_f32_16x16x32_bf16 v[84:87], a[220:223], a[172:175], v[84:87]
    v_mfma_f32_16x16x32_bf16 v[100:103], a[208:211], a[176:179], 0
    v_mfma_f32_16x16x32_bf16 v[100:103], a[212:215], a[180:183], v[100:103]
    v_mfma_f32_16x16x32_bf16 v[100:103], a[216:219], a[184:187], v[100:103]
    v_mfma_f32_16x16x32_bf16 v[100:103], a[220:223], a[188:191], v[100:103]
    v_mfma_f32_16x16x32_bf16 v[116:119], a[208:211], a[192:195], 0
    v_mfma_f32_16x16x32_bf16 v[116:119], a[212:215], a[196:199], v[116:119]
    v_mfma_f32_16x16x32_bf16 v[116:119], a[216:219], a[200:203], v[116:119]
    v_mfma_f32_16x16x32_bf16 v[116:119], a[220:223], a[204:207], v[116:119]
    s_nop 7
    ds_read_b128 a[208:211], v2 offset:8704
    ds_read_b128 a[212:215], v2 offset:8720
    ds_read_b128 a[216:219], v2 offset:8736
    ds_read_b128 a[220:223], v2 offset:8752
    s_waitcnt lgkmcnt(0)
    v_mfma_f32_16x16x32_bf16 v[72:75], a[208:211], a[144:147], 0
    v_mfma_f32_16x16x32_bf16 v[72:75], a[212:215], a[148:151], v[72:75]
    v_mfma_f32_16x16x32_bf16 v[72:75], a[216:219], a[152:155], v[72:75]
    v_mfma_f32_16x16x32_bf16 v[72:75], a[220:223], a[156:159], v[72:75]
    v_mfma_f32_16x16x32_bf16 v[88:91], a[208:211], a[160:163], 0
    v_mfma_f32_16x16x32_bf16 v[88:91], a[212:215], a[164:167], v[88:91]
    v_mfma_f32_16x16x32_bf16 v[88:91], a[216:219], a[168:171], v[88:91]
    v_mfma_f32_16x16x32_bf16 v[88:91], a[220:223], a[172:175], v[88:91]
    v_mfma_f32_16x16x32_bf16 v[104:107], a[208:211], a[176:179], 0
    v_mfma_f32_16x16x32_bf16 v[104:107], a[212:215], a[180:183], v[104:107]
    v_mfma_f32_16x16x32_bf16 v[104:107], a[216:219], a[184:187], v[104:107]
    v_mfma_f32_16x16x32_bf16 v[104:107], a[220:223], a[188:191], v[104:107]
    v_mfma_f32_16x16x32_bf16 v[120:123], a[208:211], a[192:195], 0
    v_mfma_f32_16x16x32_bf16 v[120:123], a[212:215], a[196:199], v[120:123]
    v_mfma_f32_16x16x32_bf16 v[120:123], a[216:219], a[200:203], v[120:123]
    v_mfma_f32_16x16x32_bf16 v[120:123], a[220:223], a[204:207], v[120:123]
    s_nop 7
    ds_read_b128 a[208:211], v2 offset:10880
    ds_read_b128 a[212:215], v2 offset:10896
    ds_read_b128 a[216:219], v2 offset:10912
    ds_read_b128 a[220:223], v2 offset:10928
    s_waitcnt lgkmcnt(0)
    v_mfma_f32_16x16x32_bf16 v[76:79], a[208:211], a[144:147], 0
    v_mfma_f32_16x16x32_bf16 v[76:79], a[212:215], a[148:151], v[76:79]
    v_mfma_f32_16x16x32_bf16 v[76:79], a[216:219], a[152:155], v[76:79]
    v_mfma_f32_16x16x32_bf16 v[76:79], a[220:223], a[156:159], v[76:79]
    v_mfma_f32_16x16x32_bf16 v[92:95], a[208:211], a[160:163], 0
    v_mfma_f32_16x16x32_bf16 v[92:95], a[212:215], a[164:167], v[92:95]
    v_mfma_f32_16x16x32_bf16 v[92:95], a[216:219], a[168:171], v[92:95]
    v_mfma_f32_16x16x32_bf16 v[92:95], a[220:223], a[172:175], v[92:95]
    v_mfma_f32_16x16x32_bf16 v[108:111], a[208:211], a[176:179], 0
    v_mfma_f32_16x16x32_bf16 v[108:111], a[212:215], a[180:183], v[108:111]
    v_mfma_f32_16x16x32_bf16 v[108:111], a[216:219], a[184:187], v[108:111]
    v_mfma_f32_16x16x32_bf16 v[108:111], a[220:223], a[188:191], v[108:111]
    v_mfma_f32_16x16x32_bf16 v[124:127], a[208:211], a[192:195], 0
    v_mfma_f32_16x16x32_bf16 v[124:127], a[212:215], a[196:199], v[124:127]
    v_mfma_f32_16x16x32_bf16 v[124:127], a[216:219], a[200:203], v[124:127]
    v_mfma_f32_16x16x32_bf16 v[124:127], a[220:223], a[204:207], v[124:127]
    s_nop 7
    s_nop 7
    s_cmp_lg_u32 s34, 0
    s_cbranch_scc1 L_c_acc
    v_max3_f32 v44, v64, v65, v44
    v_max3_f32 v44, v66, v67, v44
    v_max3_f32 v45, v80, v81, v45
    v_max3_f32 v45, v82, v83, v45
    v_max3_f32 v46, v96, v97, v46
    v_max3_f32 v46, v98, v99, v46
    v_max3_f32 v47, v112, v113, v47
    v_max3_f32 v47, v114, v115, v47
    v_max3_f32 v44, v68, v69, v44
    v_max3_f32 v44, v70, v71, v44
    v_max3_f32 v45, v84, v85, v45
    v_max3_f32 v45, v86, v87, v45
    v_max3_f32 v46, v100, v101, v46
    v_max3_f32 v46, v102, v103, v46
    v_max3_f32 v47, v116, v117, v47
    v_max3_f32 v47, v118, v119, v47
    v_max3_f32 v44, v72, v73, v44
    v_max3_f32 v44, v74, v75, v44
    v_max3_f32 v45, v88, v89, v45
    v_max3_f32 v45, v90, v91, v45
    v_max3_f32 v46, v104, v105, v46
    v_max3_f32 v46, v106, v107, v46
    v_max3_f32 v47, v120, v121, v47
    v_max3_f32 v47, v122, v123, v47
    v_max3_f32 v44, v76, v77, v44
    v_max3_f32 v44, v78, v79, v44
    v_max3_f32 v45, v92, v93, v45
    v_max3_f32 v45, v94, v95, v45
    v_max3_f32 v46, v108, v109, v46
    v_max3_f32 v46, v110, v111, v46
    v_max3_f32 v47, v124, v125, v47
    v_max3_f32 v47, v126, v127, v47
    s_branch L_c_next
L_c_acc:
    v_sub_f32 v64, v64, v44
    v_sub_f32 v65, v65, v44
    v_sub_f32 v66, v66, v44
    v_sub_f32 v67, v67, v44
    v_mul_f32 v64, s36, v64
    v_mul_f32 v65, s36, v65
    v_mul_f32 v66, s36, v66
    v_mul_f32 v67, s36, v67
    v_exp_f32 v64, v64
    v_exp_f32 v65, v65
    v_exp_f32 v66, v66
    v_exp_f32 v67, v67
    v_cvt_pk_bf16_f32 v128, v64, v65
    v_cvt_pk_bf16_f32 v129, v66, v67
    v_sub_f32 v80, v80, v45
    v_sub_f32 v81, v81, v45
    v_sub_f32 v82, v82, v45
    v_sub_f32 v83, v83, v45
    v_mul_f32 v80, s36, v80
    v_mul_f32 v81, s36, v81
    v_mul_f32 v82, s36, v82
    v_mul_f32 v83, s36, v83
    v_exp_f32 v80, v80
    v_exp_f32 v81, v81
    v_exp_f32 v82, v82
    v_exp_f32 v83, v83
    v_cvt_pk_bf16_f32 v136, v80, v81
    v_cvt_pk_bf16_f32 v137, v82, v83
    v_sub_f32 v96, v96, v46
    v_sub_f32 v97, v97, v46
    v_sub_f32 v98, v98, v46
    v_sub_f32 v99, v99, v46
    v_mul_f32 v96, s36, v96
    v_mul_f32 v97, s36, v97
    v_mul_f32 v98, s36, v98
    v_mul_f32 v99, s36, v99
    v_exp_f32 v96, v96
    v_exp_f32 v97, v97
    v_exp_f32 v98, v98
    v_exp_f32 v99, v99
    v_cvt_pk_bf16_f32 v144, v96, v97
    v_cvt_pk_bf16_f32 v145, v98, v99
    v_sub_f32 v112, v112, v47
    v_sub_f32 v113, v113, v47
    v_sub_f32 v114, v114, v47
    v_sub_f32 v115, v115, v47
    v_mul_f32 v112, s36, v112
    v_mul_f32 v113, s36, v113
    v_mul_f32 v114, s36, v114
    v_mul_f32 v115, s36, v115
    v_exp_f32 v112, v112
    v_exp_f32 v113, v113
    v_exp_f32 v114, v114
    v_exp_f32 v115, v115
    v_cvt_pk_bf16_f32 v152, v112, v113
    v_cvt_pk_bf16_f32 v153, v114, v115
    v_sub_f32 v68, v68, v44
    v_sub_f32 v69, v69, v44
    v_sub_f32 v70, v70, v44
    v_sub_f32 v71, v71, v44
    v_mul_f32 v68, s36, v68
    v_mul_f32 v69, s36, v69
    v_mul_f32 v70, s36, v70
    v_mul_f32 v71, s36, v71
    v_exp_f32 v68, v68
    v_exp_f32 v69, v69
    v_exp_f32 v70, v70
    v_exp_f32 v71, v71
    v_cvt_pk_bf16_f32 v130, v68, v69
    v_cvt_pk_bf16_f32 v131, v70, v71
    v_sub_f32 v84, v84, v45
    v_sub_f32 v85, v85, v45
    v_sub_f32 v86, v86, v45
    v_sub_f32 v87, v87, v45
    v_mul_f32 v84, s36, v84
    v_mul_f32 v85, s36, v85
    v_mul_f32 v86, s36, v86
    v_mul_f32 v87, s36, v87
    v_exp_f32 v84, v84
    v_exp_f32 v85, v85
    v_exp_f32 v86, v86
    v_exp_f32 v87, v87
    v_cvt_pk_bf16_f32 v138, v84, v85
    v_cvt_pk_bf16_f32 v139, v86, v87
    v_sub_f32 v100, v100, v46
    v_sub_f32 v101, v101, v46
    v_sub_f32 v102, v102, v46
    v_sub_f32 v103, v103, v46
    v_mul_f32 v100, s36, v100
    v_mul_f32 v101, s36, v101
    v_mul_f32 v102, s36, v102
    v_mul_f32 v103, s36, v103
    v_exp_f32 v100, v100
    v_exp_f32 v101, v101
    v_exp_f32 v102, v102
    v_exp_f32 v103, v103
    v_cvt_pk_bf16_f32 v146, v100, v101
    v_cvt_pk_bf16_f32 v147, v102, v103
    v_sub_f32 v116, v116, v47
    v_sub_f32 v117, v117, v47
    v_sub_f32 v118, v118, v47
    v_sub_f32 v119, v119, v47
    v_mul_f32 v116, s36, v116
    v_mul_f32 v117, s36, v117
    v_mul_f32 v118, s36, v118
    v_mul_f32 v119, s36, v119
    v_exp_f32 v116, v116
    v_exp_f32 v117, v117
    v_exp_f32 v118, v118
    v_exp_f32 v119, v119
    v_cvt_pk_bf16_f32 v154, v116, v117
    v_cvt_pk_bf16_f32 v155, v118, v119
    v_sub_f32 v72, v72, v44
    v_sub_f32 v73, v73, v44
    v_sub_f32 v74, v74, v44
    v_sub_f32 v75, v75, v44
    v_mul_f32 v72, s36, v72
    v_mul_f32 v73, s36, v73
    v_mul_f32 v74, s36, v74
    v_mul_f32 v75, s36, v75
    v_exp_f32 v72, v72
    v_exp_f32 v73, v73
    v_exp_f32 v74, v74
    v_exp_f32 v75, v75
    v_cvt_pk_bf16_f32 v132, v72, v73
    v_cvt_pk_bf16_f32 v133, v74, v75
    v_sub_f32 v88, v88, v45
    v_sub_f32 v89, v89, v45
    v_sub_f32 v90, v90, v45
    v_sub_f32 v91, v91, v45
    v_mul_f32 v88, s36, v88
    v_mul_f32 v89, s36, v89
    v_mul_f32 v90, s36, v90
    v_mul_f32 v91, s36, v91
    v_exp_f32 v88, v88
    v_exp_f32 v89, v89
    v_exp_f32 v90, v90
    v_exp_f32 v91, v91
    v_cvt_pk_bf16_f32 v140, v88, v89
    v_cvt_pk_bf16_f32 v141, v90, v91
    v_sub_f32 v104, v104, v46
    v_sub_f32 v105, v105, v46
    v_sub_f32 v106, v106, v46
    v_sub_f32 v107, v107, v46
    v_mul_f32 v104, s36, v104
    v_mul_f32 v105, s36, v105
    v_mul_f32 v106, s36, v106
    v_mul_f32 v107, s36, v107
    v_exp_f32 v104, v104
    v_exp_f32 v105, v105
    v_exp_f32 v106, v106
    v_exp_f32 v107, v107
    v_cvt_pk_bf16_f32 v148, v104, v105
    v_cvt_pk_bf16_f32 v149, v106, v107
    v_sub_f32 v120, v120, v47
    v_sub_f32 v121, v121, v47
    v_sub_f32 v122, v122, v47
    v_sub_f32 v123, v123, v47
    v_mul_f32 v120, s36, v120
    v_mul_f32 v121, s36, v121
    v_mul_f32 v122, s36, v122
    v_mul_f32 v123, s36, v123
    v_exp_f32 v120, v120
    v_exp_f32 v121, v121
    v_exp_f32 v122, v122
    v_exp_f32 v123, v123
    v_cvt_pk_bf16_f32 v156, v120, v121
    v_cvt_pk_bf16_f32 v157, v122, v123
    v_sub_f32 v76, v76, v44
    v_sub_f32 v77, v77, v44
    v_sub_f32 v78, v78, v44
    v_sub_f32 v79, v79, v44
    v_mul_f32 v76, s36, v76
    v_mul_f32 v77, s36, v77
    v_mul_f32 v78, s36, v78
    v_mul_f32 v79, s36, v79
    v_exp_f32 v76, v76
    v_exp_f32 v77, v77
    v_exp_f32 v78, v78
    v_exp_f32 v79, v79
    v_cvt_pk_bf16_f32 v134, v76, v77
    v_cvt_pk_bf16_f32 v135, v78, v79
    v_sub_f32 v92, v92, v45
    v_sub_f32 v93, v93, v45
    v_sub_f32 v94, v94, v45
    v_sub_f32 v95, v95, v45
    v_mul_f32 v92, s36, v92
    v_mul_f32 v93, s36, v93
    v_mul_f32 v94, s36, v94
    v_mul_f32 v95, s36, v95
    v_exp_f32 v92, v92
    v_exp_f32 v93, v93
    v_exp_f32 v94, v94
    v_exp_f32 v95, v95
    v_cvt_pk_bf16_f32 v142, v92, v93
    v_cvt_pk_bf16_f32 v143, v94, v95
    v_sub_f32 v108, v108, v46
    v_sub_f32 v109, v109, v46
    v_sub_f32 v110, v110, v46
    v_sub_f32 v111, v111, v46
    v_mul_f32 v108, s36, v108
    v_mul_f32 v109, s36, v109
    v_mul_f32 v110, s36, v110
    v_mul_f32 v111, s36, v111
    v_exp_f32 v108, v108
    v_exp_f32 v109, v109
    v_exp_f32 v110, v110
    v_exp_f32 v111, v111
    v_cvt_pk_bf16_f32 v150, v108, v109
    v_cvt_pk_bf16_f32 v151, v110, v111
    v_sub_f32 v124, v124, v47
    v_sub_f32 v125, v125, v47
    v_sub_f32 v126, v126, v47
    v_sub_f32 v127, v127, v47
    v_mul_f32 v124, s36, v124
    v_mul_f32 v125, s36, v125
    v_mul_f32 v126, s36, v126
    v_mul_f32 v127, s36, v127
    v_exp_f32 v124, v124
    v_exp_f32 v125, v125
    v_exp_f32 v126, v126
    v_exp_f32 v127, v127
    v_cvt_pk_bf16_f32 v158, v124, v125
    v_cvt_pk_bf16_f32 v159, v126, v127
    ds_read_b128 a[240:243], v3 offset:0
    ds_read_b128 a[244:247], v3 offset:1024
    s_waitcnt lgkmcnt(0)
    v_mfma_f32_16x16x32_bf16 a[0:3], v[128:131], a[240:243], a[0:3]
    v_mfma_f32_16x16x32_bf16 a[0:3], v[132:135], a[244:247], a[0:3]
    v_mfma_f32_16x16x32_bf16 a[4:7], v[136:139], a[240:243], a[4:7]
    v_mfma_f32_16x16x32_bf16 a[4:7], v[140:143], a[244:247], a[4:7]
    v_mfma_f32_16x16x32_bf16 a[8:11], v[144:147], a[240:243], a[8:11]
    v_mfma_f32_16x16x32_bf16 a[8:11], v[148:151], a[244:247], a[8:11]
    v_mfma_f32_16x16x32_bf16 a[12:15], v[152:155], a[240:243], a[12:15]
    v_mfma_f32_16x16x32_bf16 a[12:15], v[156:159], a[244:247], a[12:15]
    s_nop 7
    ds_read_b128 a[240:243], v3 offset:2048
    ds_read_b128 a[244:247], v3 offset:3072
    s_waitcnt lgkmcnt(0)
    v_mfma_f32_16x16x32_bf16 a[16:19], v[128:131], a[240:243], a[16:19]
    v_mfma_f32_16x16x32_bf16 a[16:19], v[132:135], a[244:247], a[16:19]
    v_mfma_f32_16x16x32_bf16 a[20:23], v[136:139], a[240:243], a[20:23]
    v_mfma_f32_16x16x32_bf16 a[20:23], v[140:143], a[244:247], a[20:23]
    v_mfma_f32_16x16x32_bf16 a[24:27], v[144:147], a[240:243], a[24:27]
    v_mfma_f32_16x16x32_bf16 a[24:27], v[148:151], a[244:247], a[24:27]
    v_mfma_f32_16x16x32_bf16 a[28:31], v[152:155], a[240:243], a[28:31]
    v_mfma_f32_16x16x32_bf16 a[28:31], v[156:159], a[244:247], a[28:31]
    s_nop 7
    ds_read_b128 a[240:243], v3 offset:4096
    ds_read_b128 a[244:247], v3 offset:5120
    s_waitcnt lgkmcnt(0)
    v_mfma_f32_16x16x32_bf16 a[32:35], v[128:131], a[240:243], a[32:35]
    v_mfma_f32_16x16x32_bf16 a[32:35], v[132:135], a[244:247], a[32:35]
    v_mfma_f32_16x16x32_bf16 a[36:39], v[136:139], a[240:243], a[36:39]
    v_mfma_f32_16x16x32_bf16 a[36:39], v[140:143], a[244:247], a[36:39]
    v_mfma_f32_16x16x32_bf16 a[40:43], v[144:147], a[240:243], a[40:43]
    v_mfma_f32_16x16x32_bf16 a[40:43], v[148:151], a[244:247], a[40:43]
    v_mfma_f32_16x16x32_bf16 a[44:47], v[152:155], a[240:243], a[44:47]
    v_mfma_f32_16x16x32_bf16 a[44:47], v[156:159], a[244:247], a[44:47]
    s_nop 7
    ds_read_b128 a[240:243], v3 offset:6144
    ds_read_b128 a[244:247], v3 offset:7168
    s_waitcnt lgkmcnt(0)
    v_mfma_f32_16x16x32_bf16 a[48:51], v[128:131], a[240:243], a[48:51]
    v_mfma_f32_16x16x32_bf16 a[48:51], v[132:135], a[244:247], a[48:51]
    v_mfma_f32_16x16x32_bf16 a[52:55], v[136:139], a[240:243], a[52:55]
    v_mfma_f32_16x16x32_bf16 a[52:55], v[140:143], a[244:247], a[52:55]
    v_mfma_f32_16x16x32_bf16 a[56:59], v[144:147], a[240:243], a[56:59]
    v_mfma_f32_16x16x32_bf16 a[56:59], v[148:151], a[244:247], a[56:59]
    v_mfma_f32_16x16x32_bf16 a[60:63], v[152:155], a[240:243], a[60:63]
    v_mfma_f32_16x16x32_bf16 a[60:63], v[156:159], a[244:247], a[60:63]
    s_nop 7
    ds_read_b128 a[240:243], v3 offset:8256
    ds_read_b128 a[244:247], v3 offset:9280
    s_waitcnt lgkmcnt(0)
    v_mfma_f32_16x16x32_bf16 a[64:67], v[128:131], a[240:243], a[64:67]
    v_mfma_f32_16x16x32_bf16 a[64:67], v[132:135], a[244:247], a[64:67]
    v_mfma_f32_16x16x32_bf16 a[68:71], v[136:139], a[240:243], a[68:71]
    v_mfma_f32_16x16x32_bf16 a[68:71], v[140:143], a[244:247], a[68:71]
    v_mfma_f32_16x16x32_bf16 a[72:75], v[144:147], a[240:243], a[72:75]
    v_mfma_f32_16x16x32_bf16 a[72:75], v[148:151], a[244:247], a[72:75]
    v_mfma_f32_16x16x32_bf16 a[76:79], v[152:155], a[240:243], a[76:79]
    v_mfma_f32_16x16x32_bf16 a[76:79], v[156:159], a[244:247], a[76:79]
    s_nop 7
    ds_read_b128 a[240:243], v3 offset:10304
    ds_read_b128 a[244:247], v3 offset:11328
    s_waitcnt lgkmcnt(0)
    v_mfma_f32_16x16x32_bf16 a[80:83], v[128:131], a[240:243], a[80:83]
    v_mfma_f32_16x16x32_bf16 a[80:83], v[132:135], a[244:247], a[80:83]
    v_mfma_f32_16x16x32_bf16 a[84:87], v[136:139], a[240:243], a[84:87]
    v_mfma_f32_16x16x32_bf16 a[84:87], v[140:143], a[244:247], a[84:87]
    v_mfma_f32_16x16x32_bf16 a[88:91], v[144:147], a[240:243], a[88:91]
    v_mfma_f32_16x16x32_bf16 a[88:91], v[148:151], a[244:247], a[88:91]
    v_mfma_f32_16x16x32_bf16 a[92:95], v[152:155], a[240:243], a[92:95]
    v_mfma_f32_16x16x32_bf16 a[92:95], v[156:159], a[244:247], a[92:95]
    s_nop 7
    ds_read_b128 a[240:243], v3 offset:12352
    ds_read_b128 a[244:247], v3 offset:13376
    s_waitcnt lgkmcnt(0)
    v_mfma_f32_16x16x32_bf16 a[96:99], v[128:131], a[240:243], a[96:99]
    v_mfma_f32_16x16x32_bf16 a[96:99], v[132:135], a[244:247], a[96:99]
    v_mfma_f32_16x16x32_bf16 a[100:103], v[136:139], a[240:243], a[100:103]
    v_mfma_f32_16x16x32_bf16 a[100:103], v[140:143], a[244:247], a[100:103]
    v_mfma_f32_16x16x32_bf16 a[104:107], v[144:147], a[240:243], a[104:107]
    v_mfma_f32_16x16x32_bf16 a[104:107], v[148:151], a[244:247], a[104:107]
    v_mfma_f32_16x16x32_bf16 a[108:111], v[152:155], a[240:243], a[108:111]
    v_mfma_f32_16x16x32_bf16 a[108:111], v[156:159], a[244:247], a[108:111]
    s_nop 7
    ds_read_b128 a[240:243], v3 offset:14400
    ds_read_b128 a[244:247], v3 offset:15424
    s_waitcnt lgkmcnt(0)
    v_mfma_f32_16x16x32_bf16 a[112:115], v[128:131], a[240:243], a[112:115]
    v_mfma_f32_16x16x32_bf16 a[112:115], v[132:135], a[244:247], a[112:115]
    v_mfma_f32_16x16x32_bf16 a[116:119], v[136:139], a[240:243], a[116:119]
    v_mfma_f32_16x16x32_bf16 a[116:119], v[140:143], a[244:247], a[116:119]
    v_mfma_f32_16x16x32_bf16 a[120:123], v[144:147], a[240:243], a[120:123]
    v_mfma_f32_16x16x32_bf16 a[120:123], v[148:151], a[244:247], a[120:123]
    v_mfma_f32_16x16x32_bf16 a[124:127], v[152:155], a[240:243], a[124:127]
    v_mfma_f32_16x16x32_bf16 a[124:127], v[156:159], a[244:247], a[124:127]
    s_nop 7
    v_mfma_f32_16x16x32_bf16 a[128:131], v[128:131], v[56:59], a[128:131]
    v_mfma_f32_16x16x32_bf16 a[128:131], v[132:135], v[56:59], a[128:131]
    v_mfma_f32_16x16x32_bf16 a[132:135], v[136:139], v[56:59], a[132:135]
    v_mfma_f32_16x16x32_bf16 a[132:135], v[140:143], v[56:59], a[132:135]
    v_mfma_f32_16x16x32_bf16 a[136:139], v[144:147], v[56:59], a[136:139]
    v_mfma_f32_16x16x32_bf16 a[136:139], v[148:151], v[56:59], a[136:139]
    v_mfma_f32_16x16x32_bf16 a[140:143], v[152:155], v[56:59], a[140:143]
    v_mfma_f32_16x16x32_bf16 a[140:143], v[156:159], v[56:59], a[140:143]
    s_nop 7
L_c_next:
    s_nop 7
    s_add_u32 s35, s35, 1
    s_cmp_lt_u32 s35, 32
    s_cbranch_scc1 L_c_tile
    s_cmp_lg_u32 s34, 0
    s_cbranch_scc1 L_c_out
    v_mov_b32 v16, v44
    s_nop 1
    v_permlane32_swap_b32 v44, v16
    v_max_f32 v44, v44, v16
    v_mov_b32 v16, v44
    s_nop 1
    v_permlane16_swap_b32 v44, v16
    v_max_f32 v44, v44, v16
    v_mov_b32 v16, v45
    s_nop 1
    v_permlane32_swap_b32 v45, v16
    v_max_f32 v45, v45, v16
    v_mov_b32 v16, v45
    s_nop 1
    v_permlane16_swap_b32 v45, v16
    v_max_f32 v45, v45, v16
    v_mov_b32 v16, v46
    s_nop 1
    v_permlane32_swap_b32 v46, v16
    v_max_f32 v46, v46, v16
    v_mov_b32 v16, v46
    s_nop 1
    v_permlane16_swap_b32 v46, v16
    v_max_f32 v46, v46, v16
    v_mov_b32 v16, v47
    s_nop 1
    v_permlane32_swap_b32 v47, v16
    v_max_f32 v47, v47, v16
    v_mov_b32 v16, v47
    s_nop 1
    v_permlane16_swap_b32 v47, v16
    v_max_f32 v47, v47, v16
    s_mov_b32 s34, 1
    s_branch L_c_pass
L_c_out:
    v_and_b32 v12, 63, v0
    v_lshlrev_b32 v12, 4, v12
    v_lshrrev_b32 v13, 6, v0
    v_lshl_add_u32 v12, v13, 14, v12
    v_add_u32 v10, 0x1000, v12
    v_add_u32 v11, 0x3000, v12
    v_accvgpr_read_b32 v24, a128
    v_accvgpr_read_b32 v25, a129
    v_accvgpr_read_b32 v26, a130
    v_accvgpr_read_b32 v27, a131
    v_rcp_f32 v24, v24
    v_rcp_f32 v25, v25
    v_rcp_f32 v26, v26
    v_rcp_f32 v27, v27
    v_accvgpr_read_b32 v64, a0
    v_accvgpr_read_b32 v65, a16
    v_accvgpr_read_b32 v66, a32
    v_accvgpr_read_b32 v67, a48
    v_accvgpr_read_b32 v68, a64
    v_accvgpr_read_b32 v69, a80
    v_accvgpr_read_b32 v70, a96
    v_accvgpr_read_b32 v71, a112
    v_mul_f32 v64, v64, v24
    v_mul_f32 v65, v65, v24
    v_mul_f32 v66, v66, v24
    v_mul_f32 v67, v67, v24
    v_mul_f32 v68, v68, v24
    v_mul_f32 v69, v69, v24
    v_mul_f32 v70, v70, v24
    v_mul_f32 v71, v71, v24
    v_cvt_pk_bf16_f32 v128, v64, v65
    v_cvt_pk_bf16_f32 v129, v66, v67
    v_cvt_pk_bf16_f32 v130, v68, v69
    v_cvt_pk_bf16_f32 v131, v70, v71
    global_store_dwordx4 v10, v[128:131], s[18:19] offset:-4096
    v_accvgpr_read_b32 v72, a1
    v_accvgpr_read_b32 v73, a17
    v_accvgpr_read_b32 v74, a33
    v_accvgpr_read_b32 v75, a49
    v_accvgpr_read_b32 v76, a65
    v_accvgpr_read_b32 v77, a81
    v_accvgpr_read_b32 v78, a97
    v_accvgpr_read_b32 v79, a113
    v_mul_f32 v72, v72, v25
    v_mul_f32 v73, v73, v25
    v_mul_f32 v74, v74, v25
    v_mul_f32 v75, v75, v25
    v_mul_f32 v76, v76, v25
    v_mul_f32 v77, v77, v25
    v_mul_f32 v78, v78, v25
    v_mul_f32 v79, v79, v25
    v_cvt_pk_bf16_f32 v132, v72, v73
    v_cvt_pk_bf16_f32 v133, v74, v75
    v_cvt_pk_bf16_f32 v134, v76, v77
    v_cvt_pk_bf16_f32 v135, v78, v79
    global_store_dwordx4 v10, v[132:135], s[18:19] offset:-3072
    v_accvgpr_read_b32 v80, a2
    v_accvgpr_read_b32 v81, a18
    v_accvgpr_read_b32 v82, a34
    v_accvgpr_read_b32 v83, a50
    v_accvgpr_read_b32 v84, a66
    v_accvgpr_read_b32 v85, a82
    v_accvgpr_read_b32 v86, a98
    v_accvgpr_read_b32 v87, a114
    v_mul_f32 v80, v80, v26
    v_mul_f32 v81, v81, v26
    v_mul_f32 v82, v82, v26
    v_mul_f32 v83, v83, v26
    v_mul_f32 v84, v84, v26
    v_mul_f32 v85, v85, v26
    v_mul_f32 v86, v86, v26
    v_mul_f32 v87, v87, v26
    v_cvt_pk_bf16_f32 v136, v80, v81
    v_cvt_pk_bf16_f32 v137, v82, v83
    v_cvt_pk_bf16_f32 v138, v84, v85
    v_cvt_pk_bf16_f32 v139, v86, v87
    global_store_dwordx4 v10, v[136:139], s[18:19] offset:-2048
    v_accvgpr_read_b32 v88, a3
    v_accvgpr_read_b32 v89, a19
    v_accvgpr_read_b32 v90, a35
    v_accvgpr_read_b32 v91, a51
    v_accvgpr_read_b32 v92, a67
    v_accvgpr_read_b32 v93, a83
    v_accvgpr_read_b32 v94, a99
    v_accvgpr_read_b32 v95, a115
    v_mul_f32 v88, v88, v27
    v_mul_f32 v89, v89, v27
    v_mul_f32 v90, v90, v27
    v_mul_f32 v91, v91, v27
    v_mul_f32 v92, v92, v27
    v_mul_f32 v93, v93, v27
    v_mul_f32 v94, v94, v27
    v_mul_f32 v95, v95, v27
    v_cvt_pk_bf16_f32 v140, v88, v89
    v_cvt_pk_bf16_f32 v141, v90, v91
    v_cvt_pk_bf16_f32 v142, v92, v93
    v_cvt_pk_bf16_f32 v143, v94, v95
    global_store_dwordx4 v10, v[140:143], s[18:19] offset:-1024
    v_accvgpr_read_b32 v24, a132
    v_accvgpr_read_b32 v25, a133
    v_accvgpr_read_b32 v26, a134
    v_accvgpr_read_b32 v27, a135
    v_rcp_f32 v24, v24
    v_rcp_f32 v25, v25
    v_rcp_f32 v26, v26
    v_rcp_f32 v27, v27
    v_accvgpr_read_b32 v96, a4
    v_accvgpr_read_b32 v97, a20
    v_accvgpr_read_b32 v98, a36
    v_accvgpr_read_b32 v99, a52
    v_accvgpr_read_b32 v100, a68
    v_accvgpr_read_b32 v101, a84
    v_accvgpr_read_b32 v102, a100
    v_accvgpr_read_b32 v103, a116
    v_mul_f32 v96, v96, v24
    v_mul_f32 v97, v97, v24
    v_mul_f32 v98, v98, v24
    v_mul_f32 v99, v99, v24
    v_mul_f32 v100, v100, v24
    v_mul_f32 v101, v101, v24
    v_mul_f32 v102, v102, v24
    v_mul_f32 v103, v103, v24
    v_cvt_pk_bf16_f32 v144, v96, v97
    v_cvt_pk_bf16_f32 v145, v98, v99
    v_cvt_pk_bf16_f32 v146, v100, v101
    v_cvt_pk_bf16_f32 v147, v102, v103
    global_store_dwordx4 v10, v[144:147], s[18:19] offset:0
    v_accvgpr_read_b32 v104, a5
    v_accvgpr_read_b32 v105, a21
    v_accvgpr_read_b32 v106, a37
    v_accvgpr_read_b32 v107, a53
    v_accvgpr_read_b32 v108, a69
    v_accvgpr_read_b32 v109, a85
    v_accvgpr_read_b32 v110, a101
    v_accvgpr_read_b32 v111, a117
    v_mul_f32 v104, v104, v25
    v_mul_f32 v105, v105, v25
    v_mul_f32 v106, v106, v25
    v_mul_f32 v107, v107, v25
    v_mul_f32 v108, v108, v25
    v_mul_f32 v109, v109, v25
    v_mul_f32 v110, v110, v25
    v_mul_f32 v111, v111, v25
    v_cvt_pk_bf16_f32 v148, v104, v105
    v_cvt_pk_bf16_f32 v149, v106, v107
    v_cvt_pk_bf16_f32 v150, v108, v109
    v_cvt_pk_bf16_f32 v151, v110, v111
    global_store_dwordx4 v10, v[148:151], s[18:19] offset:1024
    v_accvgpr_read_b32 v112, a6
    v_accvgpr_read_b32 v113, a22
    v_accvgpr_read_b32 v114, a38
    v_accvgpr_read_b32 v115, a54
    v_accvgpr_read_b32 v116, a70
    v_accvgpr_read_b32 v117, a86
    v_accvgpr_read_b32 v118, a102
    v_accvgpr_read_b32 v119, a118
    v_mul_f32 v112, v112, v26
    v_mul_f32 v113, v113, v26
    v_mul_f32 v114, v114, v26
    v_mul_f32 v115, v115, v26
    v_mul_f32 v116, v116, v26
    v_mul_f32 v117, v117, v26
    v_mul_f32 v118, v118, v26
    v_mul_f32 v119, v119, v26
    v_cvt_pk_bf16_f32 v152, v112, v113
    v_cvt_pk_bf16_f32 v153, v114, v115
    v_cvt_pk_bf16_f32 v154, v116, v117
    v_cvt_pk_bf16_f32 v155, v118, v119
    global_store_dwordx4 v10, v[152:155], s[18:19] offset:2048
    v_accvgpr_read_b32 v120, a7
    v_accvgpr_read_b32 v121, a23
    v_accvgpr_read_b32 v122, a39
    v_accvgpr_read_b32 v123, a55
    v_accvgpr_read_b32 v124, a71
    v_accvgpr_read_b32 v125, a87
    v_accvgpr_read_b32 v126, a103
    v_accvgpr_read_b32 v127, a119
    v_mul_f32 v120, v120, v27
    v_mul_f32 v121, v121, v27
    v_mul_f32 v122, v122, v27
    v_mul_f32 v123, v123, v27
    v_mul_f32 v124, v124, v27
    v_mul_f32 v125, v125, v27
    v_mul_f32 v126, v126, v27
    v_mul_f32 v127, v127, v27
    v_cvt_pk_bf16_f32 v156, v120, v121
    v_cvt_pk_bf16_f32 v157, v122, v123
    v_cvt_pk_bf16_f32 v158, v124, v125
    v_cvt_pk_bf16_f32 v159, v126, v127
    global_store_dwordx4 v10, v[156:159], s[18:19] offset:3072
    v_accvgpr_read_b32 v24, a136
    v_accvgpr_read_b32 v25, a137
    v_accvgpr_read_b32 v26, a138
    v_accvgpr_read_b32 v27, a139
    v_rcp_f32 v24, v24
    v_rcp_f32 v25, v25
    v_rcp_f32 v26, v26
    v_rcp_f32 v27, v27
    v_accvgpr_read_b32 v64, a8
    v_accvgpr_read_b32 v65, a24
    v_accvgpr_read_b32 v66, a40
    v_accvgpr_read_b32 v67, a56
    v_accvgpr_read_b32 v68, a72
    v_accvgpr_read_b32 v69, a88
    v_accvgpr_read_b32 v70, a104
    v_accvgpr_read_b32 v71, a120
    v_mul_f32 v64, v64, v24
    v_mul_f32 v65, v65, v24
    v_mul_f32 v66, v66, v24
    v_mul_f32 v67, v67, v24
    v_mul_f32 v68, v68, v24
    v_mul_f32 v69, v69, v24
    v_mul_f32 v70, v70, v24
    v_mul_f32 v71, v71, v24
    v_cvt_pk_bf16_f32 v128, v64, v65
    v_cvt_pk_bf16_f32 v129, v66, v67
    v_cvt_pk_bf16_f32 v130, v68, v69
    v_cvt_pk_bf16_f32 v131, v70, v71
    global_store_dwordx4 v11, v[128:131], s[18:19] offset:-4096
    v_accvgpr_read_b32 v72, a9
    v_accvgpr_read_b32 v73, a25
    v_accvgpr_read_b32 v74, a41
    v_accvgpr_read_b32 v75, a57
    v_accvgpr_read_b32 v76, a73
    v_accvgpr_read_b32 v77, a89
    v_accvgpr_read_b32 v78, a105
    v_accvgpr_read_b32 v79, a121
    v_mul_f32 v72, v72, v25
    v_mul_f32 v73, v73, v25
    v_mul_f32 v74, v74, v25
    v_mul_f32 v75, v75, v25
    v_mul_f32 v76, v76, v25
    v_mul_f32 v77, v77, v25
    v_mul_f32 v78, v78, v25
    v_mul_f32 v79, v79, v25
    v_cvt_pk_bf16_f32 v132, v72, v73
    v_cvt_pk_bf16_f32 v133, v74, v75
    v_cvt_pk_bf16_f32 v134, v76, v77
    v_cvt_pk_bf16_f32 v135, v78, v79
    global_store_dwordx4 v11, v[132:135], s[18:19] offset:-3072
    v_accvgpr_read_b32 v80, a10
    v_accvgpr_read_b32 v81, a26
    v_accvgpr_read_b32 v82, a42
    v_accvgpr_read_b32 v83, a58
    v_accvgpr_read_b32 v84, a74
    v_accvgpr_read_b32 v85, a90
    v_accvgpr_read_b32 v86, a106
    v_accvgpr_read_b32 v87, a122
    v_mul_f32 v80, v80, v26
    v_mul_f32 v81, v81, v26
    v_mul_f32 v82, v82, v26
    v_mul_f32 v83, v83, v26
    v_mul_f32 v84, v84, v26
    v_mul_f32 v85, v85, v26
    v_mul_f32 v86, v86, v26
    v_mul_f32 v87, v87, v26
    v_cvt_pk_bf16_f32 v136, v80, v81
    v_cvt_pk_bf16_f32 v137, v82, v83
    v_cvt_pk_bf16_f32 v138, v84, v85
    v_cvt_pk_bf16_f32 v139, v86, v87
    global_store_dwordx4 v11, v[136:139], s[18:19] offset:-2048
    v_accvgpr_read_b32 v88, a11
    v_accvgpr_read_b32 v89, a27
    v_accvgpr_read_b32 v90, a43
    v_accvgpr_read_b32 v91, a59
    v_accvgpr_read_b32 v92, a75
    v_accvgpr_read_b32 v93, a91
    v_accvgpr_read_b32 v94, a107
    v_accvgpr_read_b32 v95, a123
    v_mul_f32 v88, v88, v27
    v_mul_f32 v89, v89, v27
    v_mul_f32 v90, v90, v27
    v_mul_f32 v91, v91, v27
    v_mul_f32 v92, v92, v27
    v_mul_f32 v93, v93, v27
    v_mul_f32 v94, v94, v27
    v_mul_f32 v95, v95, v27
    v_cvt_pk_bf16_f32 v140, v88, v89
    v_cvt_pk_bf16_f32 v141, v90, v91
    v_cvt_pk_bf16_f32 v142, v92, v93
    v_cvt_pk_bf16_f32 v143, v94, v95
    global_store_dwordx4 v11, v[140:143], s[18:19] offset:-1024
    v_accvgpr_read_b32 v24, a140
    v_accvgpr_read_b32 v25, a141
    v_accvgpr_read_b32 v26, a142
    v_accvgpr_read_b32 v27, a143
    v_rcp_f32 v24, v24
    v_rcp_f32 v25, v25
    v_rcp_f32 v26, v26
    v_rcp_f32 v27, v27
    v_accvgpr_read_b32 v96, a12
    v_accvgpr_read_b32 v97, a28
    v_accvgpr_read_b32 v98, a44
    v_accvgpr_read_b32 v99, a60
    v_accvgpr_read_b32 v100, a76
    v_accvgpr_read_b32 v101, a92
    v_accvgpr_read_b32 v102, a108
    v_accvgpr_read_b32 v103, a124
    v_mul_f32 v96, v96, v24
    v_mul_f32 v97, v97, v24
    v_mul_f32 v98, v98, v24
    v_mul_f32 v99, v99, v24
    v_mul_f32 v100, v100, v24
    v_mul_f32 v101, v101, v24
    v_mul_f32 v102, v102, v24
    v_mul_f32 v103, v103, v24
    v_cvt_pk_bf16_f32 v144, v96, v97
    v_cvt_pk_bf16_f32 v145, v98, v99
    v_cvt_pk_bf16_f32 v146, v100, v101
    v_cvt_pk_bf16_f32 v147, v102, v103
    global_store_dwordx4 v11, v[144:147], s[18:19] offset:0
    v_accvgpr_read_b32 v104, a13
    v_accvgpr_read_b32 v105, a29
    v_accvgpr_read_b32 v106, a45
    v_accvgpr_read_b32 v107, a61
    v_accvgpr_read_b32 v108, a77
    v_accvgpr_read_b32 v109, a93
    v_accvgpr_read_b32 v110, a109
    v_accvgpr_read_b32 v111, a125
    v_mul_f32 v104, v104, v25
    v_mul_f32 v105, v105, v25
    v_mul_f32 v106, v106, v25
    v_mul_f32 v107, v107, v25
    v_mul_f32 v108, v108, v25
    v_mul_f32 v109, v109, v25
    v_mul_f32 v110, v110, v25
    v_mul_f32 v111, v111, v25
    v_cvt_pk_bf16_f32 v148, v104, v105
    v_cvt_pk_bf16_f32 v149, v106, v107
    v_cvt_pk_bf16_f32 v150, v108, v109
    v_cvt_pk_bf16_f32 v151, v110, v111
    global_store_dwordx4 v11, v[148:151], s[18:19] offset:1024
    v_accvgpr_read_b32 v112, a14
    v_accvgpr_read_b32 v113, a30
    v_accvgpr_read_b32 v114, a46
    v_accvgpr_read_b32 v115, a62
    v_accvgpr_read_b32 v116, a78
    v_accvgpr_read_b32 v117, a94
    v_accvgpr_read_b32 v118, a110
    v_accvgpr_read_b32 v119, a126
    v_mul_f32 v112, v112, v26
    v_mul_f32 v113, v113, v26
    v_mul_f32 v114, v114, v26
    v_mul_f32 v115, v115, v26
    v_mul_f32 v116, v116, v26
    v_mul_f32 v117, v117, v26
    v_mul_f32 v118, v118, v26
    v_mul_f32 v119, v119, v26
    v_cvt_pk_bf16_f32 v152, v112, v113
    v_cvt_pk_bf16_f32 v153, v114, v115
    v_cvt_pk_bf16_f32 v154, v116, v117
    v_cvt_pk_bf16_f32 v155, v118, v119
    global_store_dwordx4 v11, v[152:155], s[18:19] offset:2048
    v_accvgpr_read_b32 v120, a15
    v_accvgpr_read_b32 v121, a31
    v_accvgpr_read_b32 v122, a47
    v_accvgpr_read_b32 v123, a63
    v_accvgpr_read_b32 v124, a79
    v_accvgpr_read_b32 v125, a95
    v_accvgpr_read_b32 v126, a111
    v_accvgpr_read_b32 v127, a127
    v_mul_f32 v120, v120, v27
    v_mul_f32 v121, v121, v27
    v_mul_f32 v122, v122, v27
    v_mul_f32 v123, v123, v27
    v_mul_f32 v124, v124, v27
    v_mul_f32 v125, v125, v27
    v_mul_f32 v126, v126, v27
    v_mul_f32 v127, v127, v27
    v_cvt_pk_bf16_f32 v156, v120, v121
    v_cvt_pk_bf16_f32 v157, v122, v123
    v_cvt_pk_bf16_f32 v158, v124, v125
    v_cvt_pk_bf16_f32 v159, v126, v127
    global_store_dwordx4 v11, v[156:159], s[18:19] offset:3072
L_end:
    s_endpgm
.section .rodata,"a"
.p2align 6
.amdhsa_kernel standalone__kv_cache_quant_int4_int2_kv_with_per_channel_or_per_token_scales__prompt_kernel
  .amdhsa_next_free_vgpr 512
  .amdhsa_next_free_sgpr 102
  .amdhsa_accum_offset 256
  .amdhsa_group_segment_fixed_size 0
  .amdhsa_kernarg_size 80
  .amdhsa_user_sgpr_count 2
  .amdhsa_user_sgpr_kernarg_segment_ptr 1
  .amdhsa_system_sgpr_workgroup_id_x 1
  .amdhsa_float_denorm_mode_32 3
.end_amdhsa_kernel
```
